```python
import torch

def _softmax(x, axis=-1):
    return torch.softmax(x, dim=axis)
def _gelu(x):
    return torch.nn.functional.gelu(x, approximate="tanh")
def _silu(x):
    return torch.nn.functional.silu(x)
def _sigmoid(x):
    return torch.sigmoid(x)
def _layernorm(x, axis=-1, eps=1e-5):
    m = x.mean(dim=axis, keepdim=True)
    v = x.var(dim=axis, keepdim=True, unbiased=False)
    return (x - m) / torch.sqrt(v + eps)
def _scatter_add(tgt, idx, src, axis=0):
    return tgt.clone().index_add_(axis, idx, src)
def _segment_sum(src, seg, n):
    out = torch.zeros((n,) + src.shape[1:], dtype=src.dtype)
    return out.index_add_(0, seg, src)
def _pad(x, pw):
    flat = tuple(v for pair in reversed(pw) for v in pair)
    return torch.nn.functional.pad(x, flat)

kernel_name = 'sequential_preLN__sliding_block_cached__mixer_channel_mlp__decode'

def setup_inputs():

    _w = (lambda a: (lambda t: t.to(torch.bfloat16) if t.is_floating_point() else t)(torch.as_tensor(a)))
    def _A_setup():
        B, Sq, D = 1, 1, 576
        Hq, Hkv, Sk, Dh = 32, 16, 65536, 128
        assert Hq % Hkv == 0, (Hq, Hkv)
        return {
            "x": _w((lambda *s: torch.randn(*s, dtype=torch.bfloat16) * 0.05)(B, Sq, D)),
            "k_cache": _w((lambda *s: torch.randn(*s, dtype=torch.bfloat16) * 3.2)(B, Hkv, Sk, Dh)),
            "v_cache": _w((lambda *s: torch.randn(*s, dtype=torch.bfloat16) * 0.4)(B, Hkv, Sk, Dh)),
            "wq": _w((lambda *s: torch.randn(*s, dtype=torch.bfloat16) * 3.2)(D, Hq * Dh) * (D ** -0.5)),
            "wo": _w((lambda *s: torch.randn(*s, dtype=torch.bfloat16) * 0.4)(Hq * Dh, D) * ((Hq * Dh) ** -0.5)),
        }
    _A_in = _A_setup()

    def _B_setup():
        B, S, D, F = 1, 1, 576, 4608
        return {
            "x": _w((lambda *s: torch.randn(*s, dtype=torch.bfloat16) * 0.05)(B, S, D)),
            "w1": _w((lambda *s: torch.randn(*s, dtype=torch.bfloat16) * 3.2)(D, F) * (D ** -0.5)),
            "b1": _w((lambda *s: torch.randn(*s, dtype=torch.bfloat16) * 3.2)(F)),
            "w2": _w((lambda *s: torch.randn(*s, dtype=torch.bfloat16) * 0.1)(F, D) * (F ** -0.5)),
            "b2": _w((lambda *s: torch.randn(*s, dtype=torch.bfloat16) * 0.1)(D)),
        }
    _B_in = _B_setup()

    return {
        "A_x": _A_in["x"],
        "A_k_cache": _A_in["k_cache"],
        "A_v_cache": _A_in["v_cache"],
        "A_wq": _A_in["wq"],
        "A_wo": _A_in["wo"],
        "B_x": _B_in["x"],
        "B_w1": _B_in["w1"],
        "B_b1": _B_in["b1"],
        "B_w2": _B_in["w2"],
        "B_b2": _B_in["b2"],
    }

def reference(A_x, A_k_cache, A_v_cache, A_wq, A_wo, B_x, B_w1, B_b1, B_w2, B_b2):
    def _A_ref(x, k_cache, v_cache, wq, wo):
        B, Sq, D = x.shape
        Hq, Dh = 32, 128
        Hkv, Sk = k_cache.shape[1], k_cache.shape[2]
        W = min(4096, max(256, Sk // 4))
        rep = Hq // Hkv
        q = (lambda x, *d: x.permute(*d))((x @ wq).reshape(B, Sq, Hq, Dh), 0, 2, 1, 3)
        k = (lambda x, n, axis: torch.repeat_interleave(x, n, dim=axis))(k_cache[:, :, Sk - W:, :], rep, axis=1)
        v = (lambda x, n, axis: torch.repeat_interleave(x, n, dim=axis))(v_cache[:, :, Sk - W:, :], rep, axis=1)
        scores = torch.einsum("bhqd,bhkd->bhqk", q, k) * (Dh ** -0.5)
        p = _softmax(scores, axis=-1)
        o = torch.einsum("bhqk,bhkd->bhqd", p, v)
        return (lambda x, *d: x.permute(*d))(o, 0, 2, 1, 3).reshape(B, Sq, Hq * Dh) @ wo

    def _B_ref(x, w1, b1, w2, b2):
        y = _layernorm(x, axis=-1)
        h = _gelu(torch.einsum("bsd,df->bsf", y, w1) + b1)
        return torch.einsum("bsf,fd->bsd", h, w2) + b2

    x = A_x
    h = x + _A_ref(_layernorm(x, axis=-1), A_k_cache, A_v_cache, A_wq, A_wo)
    h2 = h + _B_ref(_layernorm(h, axis=-1), B_w1, B_b1, B_w2, B_b2)
    return h2
```

```asm
; @launch grid=(256,1,1) block=(640,1,1) lds=20016
.amdgcn_target "amdgcn-amd-amdhsa--gfx950"
.text
.globl sequential_preLN__sliding_block_cached__mixer_channel_mlp__decode_kernel
.p2align 8
.type sequential_preLN__sliding_block_cached__mixer_channel_mlp__decode_kernel,@function
sequential_preLN__sliding_block_cached__mixer_channel_mlp__decode_kernel:
    s_cmp_ge_u32 s2, 256
    s_cbranch_scc1 L_END
    s_load_dwordx16 s[4:19], s[0:1], 0
    s_load_dwordx8 s[20:27], s[0:1], 64
    s_load_dwordx2 s[28:29], s[0:1], 96
    v_lshrrev_b32 v1, 6, v0
    v_and_b32 v0, 63, v0
    v_readfirstlane_b32 s35, v1
    s_and_b32 s36, s2, 7
    s_lshr_b32 s37, s2, 3
    s_bfe_u32 s38, s2, 0x30004
    s_xor_b32 s36, s36, s38
    s_and_b32 s47, s37, 1
    s_lshl1_add_u32 s38, s36, s47
    s_and_b32 s36, 7, s2
    s_lshr_b32 s39, s37, 1
    s_bfe_u32 s40, s39, 0x20001
    s_and_b32 s41, s39, 1
    s_lshr_b32 s42, s39, 3
    s_lshl1_add_u32 s41, s42, s41
    s_cmp_eq_u32 s35, 9
    s_cbranch_scc1 L_C
    s_mul_i32 s42, s41, 144
    s_lshl_b32 s43, s35, 4
    s_add_u32 s42, s42, s43
    v_lshrrev_b32 v1, 3, v0
    v_and_b32 v2, 7, v0
    v_lshlrev_b32 v3, 4, v0
    v_lshlrev_b32 v4, 1, v0
    s_lshl_b32 s43, s42, 1
    v_lshl_add_u32 v5, v1, 2, s43
    s_lshl_b32 s43, s42, 13
    s_lshl_b32 s44, s38, 9
    s_add_u32 s43, s43, s44
    s_lshl_b32 s44, s40, 7
    s_add_u32 s43, s43, s44
    v_lshlrev_b32 v6, 14, v1
    v_lshl_add_u32 v6, v2, 4, v6
    v_add_u32 v6, s43, v6
    v_add_u32 v7, 0x2000, v6
    s_waitcnt lgkmcnt(0)
    global_load_dwordx4 v[112:115], v3, s[4:5]
    global_load_ushort v116, v4, s[4:5] offset:1024
    global_load_dword v117, v5, s[4:5]
    global_load_dwordx4 v[104:107], v6, s[10:11] nt
    global_load_dwordx4 v[108:111], v7, s[10:11] nt
    s_load_dword s30, s[28:29], 0
    s_lshl_b32 s96, s39, 3
    s_mov_b32 s97, 8
    s_lshl_b32 s43, s38, 24
    s_add_u32 s44, s96, s35
    s_lshl_b32 s44, s44, 10
    s_mov_b32 s63, 0x20000
    s_add_u32 s43, s43, s44
    s_add_u32 s43, s43, 15728640
    v_add_u32 v11, s43, v3
    v_bfe_u32 v7, v0, 2, 2
    v_lshrrev_b32 v8, 4, v0
    v_lshlrev_b32 v10, 8, v7
    v_lshl_add_u32 v10, v8, 6, v10
    v_and_b32 v7, 3, v0
    v_lshl_add_u32 v10, v7, 4, v10
    v_add_u32 v10, s43, v10
    s_barrier
    s_cmp_ge_u32 s35, s97
    s_cbranch_scc1 L_NOK
    global_load_dwordx4 v[40:43], v10, s[6:7] nt
    v_add_u32 v10, s63, v10
    global_load_dwordx4 v[44:47], v10, s[6:7] nt
    v_add_u32 v10, s63, v10
L_NOK:
    s_mov_b32 s59, 0x3f803f80
    v_mov_b32 v9, 0xff
    v_mov_b32 v161, 0x3f80
    v_mov_b32 v162, 0x3f800000
    v_mov_b32 v12, 0xffff
    v_mov_b32 v13, 0xffff0000
    v_and_b32 v14, 1, v0
    v_cmp_eq_u32 vcc, 1, v14
    s_nop 1
    v_cndmask_b32 v14, v12, v13, vcc
    v_bfe_u32 v15, v0, 1, 2
    s_mul_i32 s43, s35, 640
    v_lshrrev_b32 v16, 5, v0
    v_mul_u32_u24 v16, 320, v16
    v_lshl_add_u32 v16, v2, 5, v16
    v_bfe_u32 v17, v0, 4, 1
    v_lshl_add_u32 v16, v17, 4, v16
    v_add_u32 v167, s43, v16
    v_cmp_eq_u32 vcc, 0, v15
    s_nop 1
    v_cndmask_b32 v1, 0, v14, vcc
    v_cmp_eq_u32 vcc, 1, v15
    s_nop 1
    v_cndmask_b32 v2, 0, v14, vcc
    v_cmp_eq_u32 vcc, 2, v15
    s_nop 1
    v_cndmask_b32 v3, 0, v14, vcc
    v_cmp_eq_u32 vcc, 3, v15
    s_nop 1
    v_cndmask_b32 v4, 0, v14, vcc
    s_cmp_lt_u32 s35, s97
    s_cbranch_scc1 L_NOINIT
    s_waitcnt vmcnt(2)
L_NOINIT:
    s_waitcnt vmcnt(4)
    v_dot2_f32_bf16 v12, v112, s59, 0
    v_dot2_f32_bf16 v13, v112, v112, 0
    v_dot2_f32_bf16 v12, v113, s59, v12
    v_dot2_f32_bf16 v13, v113, v113, v13
    v_dot2_f32_bf16 v12, v114, s59, v12
    v_dot2_f32_bf16 v13, v114, v114, v13
    v_dot2_f32_bf16 v12, v115, s59, v12
    v_dot2_f32_bf16 v13, v115, v115, v13
    v_dot2_f32_bf16 v12, v116, s59, v12
    v_dot2_f32_bf16 v13, v116, v116, v13
    s_nop 1
    v_add_f32_dpp v12, v12, v12 quad_perm:[1,0,3,2] row_mask:0xf bank_mask:0xf
    v_add_f32_dpp v13, v13, v13 quad_perm:[1,0,3,2] row_mask:0xf bank_mask:0xf
    s_nop 0
    v_add_f32_dpp v12, v12, v12 quad_perm:[2,3,0,1] row_mask:0xf bank_mask:0xf
    v_add_f32_dpp v13, v13, v13 quad_perm:[2,3,0,1] row_mask:0xf bank_mask:0xf
    s_nop 0
    v_add_f32_dpp v12, v12, v12 row_half_mirror row_mask:0xf bank_mask:0xf
    v_add_f32_dpp v13, v13, v13 row_half_mirror row_mask:0xf bank_mask:0xf
    s_nop 0
    v_add_f32_dpp v12, v12, v12 row_mirror row_mask:0xf bank_mask:0xf
    v_add_f32_dpp v13, v13, v13 row_mirror row_mask:0xf bank_mask:0xf
    s_nop 0
    v_add_f32_dpp v12, v12, v12 row_bcast:15 row_mask:0xa bank_mask:0xf
    v_add_f32_dpp v13, v13, v13 row_bcast:15 row_mask:0xa bank_mask:0xf
    s_nop 0
    v_add_f32_dpp v12, v12, v12 row_bcast:31 row_mask:0xc bank_mask:0xf
    v_add_f32_dpp v13, v13, v13 row_bcast:31 row_mask:0xc bank_mask:0xf
    v_mul_f32 v12, 0xbae38e39, v12
    v_mul_f32 v13, 0x3ae38e39, v13
    v_fma_f32 v13, -v12, v12, v13
    v_cvt_pk_bf16_f32 v14, 0, v12
    v_max_f32 v13, 0, v13
    v_cvt_pk_bf16_f32 v15, 0, v13
    v_readlane_b32 s46, v14, 63
    v_add_f32 v15, 0x3727c5ac, v15
    v_cvt_pk_bf16_f32 v15, 0, v15
    v_sqrt_f32 v15, v15
    v_dot2_f32_bf16 v16, v117, v161, s46
    v_dot2_f32_bf16 v17, v117, v162, s46
    v_cvt_pk_bf16_f32 v15, 0, v15
    v_rcp_f32 v15, v15
    v_cvt_pk_bf16_f32 v16, 0, v16
    v_readlane_b32 s48, v15, 63
    v_cvt_pk_bf16_f32 v17, 0, v17
    s_nop 0
    v_pk_mul_f32 v[16:17], v[16:17], s[48:49] op_sel_hi:[1,0]
    s_nop 0
    v_cvt_pk_bf16_f32 v16, v16, v16
    v_cvt_pk_bf16_f32 v17, v17, v17
    v_and_b32 v20, v16, v1
    v_and_b32 v21, v16, v2
    v_and_b32 v22, v16, v3
    v_and_b32 v23, v16, v4
    v_and_b32 v24, v17, v1
    v_and_b32 v25, v17, v2
    v_and_b32 v26, v17, v3
    v_and_b32 v27, v17, v4
    s_cmp_lt_u32 s35, s97
    s_cbranch_scc1 L_W0
    s_waitcnt vmcnt(0)
L_W0:
    s_waitcnt vmcnt(2)
    v_mfma_f32_16x16x32_bf16 v[12:15], v[20:23], v[104:107], 0
    v_mfma_f32_16x16x32_bf16 v[12:15], v[24:27], v[108:111], v[12:15]
    s_mov_b32 exec_lo, 0xff00ff
    s_mov_b32 exec_hi, 0xff00ff00
    s_nop 5
    ds_write_b128 v167, v[12:15] offset:0
    s_mov_b64 exec, 1
    ds_add_u32 v0, v9 offset:16152
    s_mov_b64 exec, -1
    s_cmp_ge_u32 s35, s97
    s_cbranch_scc1 L_NOK2
    global_load_dwordx4 v[48:51], v10, s[6:7] nt
    v_add_u32 v10, s63, v10
    global_load_dwordx4 v[52:55], v10, s[6:7] nt
    v_add_u32 v10, s63, v10
L_NOK2:
    s_waitcnt lgkmcnt(0)
    s_mul_i32 s31, s30, 0x9e3779b1
    s_lshr_b32 s32, s30, 13
    s_xor_b32 s31, s31, s32
    s_and_b32 s31, s31, 0x7e7e7e7e
    s_or_b32 s31, s31, 0x01010101
    s_add_u32 s30, s31, s30
    s_and_b32 s31, s30, 0xff
    s_bfe_u32 s32, s30, 0x80008
    s_bfe_u32 s33, s30, 0x80010
    s_lshr_b32 s34, s30, 24
    v_lshrrev_b32 v12, 2, v0
    v_and_b32 v13, 1, v0
    v_lshlrev_b32 v14, 8, v13
    v_lshl_add_u32 v14, v12, 4, v14
    v_add_u32 v14, 15616, v14
    v_mov_b32 v15, 16128
    v_and_b32 v16, 2, v0
    v_cmp_eq_u32 vcc, 0, v16
    s_nop 1
    v_cndmask_b32 v166, v15, v14, vcc
    v_cndmask_b32 v165, v14, v15, vcc
    v_mov_b32 v164, 0
    s_lshl_b32 s43, s35, 4
    v_lshl_add_u32 v163, v13, 3, s43
    v_mov_b32 v12, 0xffff
    v_mov_b32 v13, 0xffff0000
    v_and_b32 v14, 2, v0
    v_cmp_eq_u32 vcc, 2, v14
    s_nop 1
    v_cndmask_b32 v14, v12, v13, vcc
    v_bfe_u32 v15, v0, 2, 2
    v_cmp_eq_u32 vcc, 0, v15
    s_nop 1
    v_cndmask_b32 v5, 0, v14, vcc
    v_cmp_eq_u32 vcc, 1, v15
    s_nop 1
    v_cndmask_b32 v6, 0, v14, vcc
    v_cmp_eq_u32 vcc, 2, v15
    s_nop 1
    v_cndmask_b32 v7, 0, v14, vcc
    v_cmp_eq_u32 vcc, 3, v15
    s_nop 1
    v_cndmask_b32 v8, 0, v14, vcc
    s_mov_b32 s60, 0x3fb8aa3b
    s_cmp_lt_u32 s37, 18
    s_cbranch_scc1 L_M
    s_cmp_lt_u32 s37, 27
    s_cbranch_scc1 L_O
    s_sub_u32 s50, s37, 27
    s_lshl3_add_u32 s50, s50, s36
    s_cmp_ge_u32 s35, s97
    s_cbranch_scc1 IDLE_1
    s_mov_b32 s62, 0
    s_waitcnt vmcnt(3)
    global_load_dwordx4 v[56:59], v10, s[6:7] nt
    v_add_u32 v10, s63, v10
    s_waitcnt vmcnt(3)
    global_load_dwordx4 v[60:63], v10, s[6:7] nt
    v_add_u32 v10, s63, v10
    s_waitcnt vmcnt(3)
    global_load_dwordx4 v[64:67], v10, s[6:7] nt
    v_add_u32 v10, s63, v10
    s_waitcnt vmcnt(3)
    global_load_dwordx4 v[68:71], v10, s[6:7] nt
    s_waitcnt vmcnt(3)
    global_load_dwordx4 v[72:75], v11, s[8:9] nt
    v_add_u32 v11, s63, v11
    s_waitcnt vmcnt(3)
    global_load_dwordx4 v[76:79], v11, s[8:9] nt
    v_add_u32 v11, s63, v11
    s_waitcnt vmcnt(3)
    global_load_dwordx4 v[80:83], v11, s[8:9] nt
    v_add_u32 v11, s63, v11
    s_waitcnt vmcnt(3)
    global_load_dwordx4 v[84:87], v11, s[8:9] nt
    v_add_u32 v11, s63, v11
    ds_read_b32 v160, v164 offset:16160
    ds_read_b128 v[152:155], v166
    ds_read_b128 v[156:159], v165
    s_waitcnt lgkmcnt(2)
    v_readfirstlane_b32 s61, v160
    s_nop 0
    s_cmp_eq_u32 s61, 0
    s_nop 1
    s_cbranch_scc1 QN_7
    s_mov_b32 s62, 1
    s_branch QS_3
QN_7:
    s_waitcnt vmcnt(3)
    global_load_dwordx4 v[88:91], v11, s[8:9] nt
    v_add_u32 v11, s63, v11
    s_cmp_lg_u32 s62, 0
    s_cbranch_scc1 QN_8
    ds_read_b32 v160, v164 offset:16160
    ds_read_b128 v[152:155], v166
    ds_read_b128 v[156:159], v165
    s_waitcnt lgkmcnt(2)
    v_readfirstlane_b32 s61, v160
    s_nop 0
    s_cmp_eq_u32 s61, 0
    s_nop 1
    s_cbranch_scc1 QN_8
    s_mov_b32 s62, 2
    s_branch QS_3
QN_8:
    s_waitcnt vmcnt(3)
    global_load_dwordx4 v[92:95], v11, s[8:9] nt
    v_add_u32 v11, s63, v11
    s_cmp_lg_u32 s62, 0
    s_cbranch_scc1 QN_9
    ds_read_b32 v160, v164 offset:16160
    ds_read_b128 v[152:155], v166
    ds_read_b128 v[156:159], v165
    s_waitcnt lgkmcnt(2)
    v_readfirstlane_b32 s61, v160
    s_nop 0
    s_cmp_eq_u32 s61, 0
    s_nop 1
    s_cbranch_scc1 QN_9
    s_mov_b32 s62, 3
    s_branch QS_3
QN_9:
    s_waitcnt vmcnt(3)
    global_load_dwordx4 v[96:99], v11, s[8:9] nt
    v_add_u32 v11, s63, v11
    s_cmp_lg_u32 s62, 0
    s_cbranch_scc1 QN_10
    ds_read_b32 v160, v164 offset:16160
    ds_read_b128 v[152:155], v166
    ds_read_b128 v[156:159], v165
    s_waitcnt lgkmcnt(2)
    v_readfirstlane_b32 s61, v160
    s_nop 0
    s_cmp_eq_u32 s61, 0
    s_nop 1
    s_cbranch_scc1 QN_10
    s_mov_b32 s62, 4
    s_branch QS_3
QN_10:
    s_waitcnt vmcnt(3)
    global_load_dwordx4 v[100:103], v11, s[8:9] nt
    s_cmp_lg_u32 s62, 0
    s_cbranch_scc1 PV_4
    s_mov_b32 s58, 0
QSPIN_5:
    ds_read_b32 v160, v164 offset:16160
    ds_read_b128 v[152:155], v166
    ds_read_b128 v[156:159], v165
    s_add_u32 s58, s58, 1
    s_waitcnt lgkmcnt(2)
    v_readfirstlane_b32 s61, v160
    s_cmp_ge_u32 s58, 480000
    s_nop 2
    s_cbranch_scc1 QS_3
    s_cmp_eq_u32 s61, 0
    s_cbranch_scc1 QSPIN_5
QS_3:
    s_waitcnt lgkmcnt(1)
    v_mfma_f32_16x16x32_bf16 v[12:15], v[40:43], v[152:155], 0
    v_mfma_f32_16x16x32_bf16 v[16:19], v[48:51], v[152:155], 0
    v_mfma_f32_16x16x32_bf16 v[20:23], v[56:59], v[152:155], 0
    v_mfma_f32_16x16x32_bf16 v[24:27], v[64:67], v[152:155], 0
    s_waitcnt lgkmcnt(0)
    v_mfma_f32_16x16x32_bf16 v[12:15], v[44:47], v[156:159], v[12:15]
    v_mfma_f32_16x16x32_bf16 v[16:19], v[52:55], v[156:159], v[16:19]
    v_mfma_f32_16x16x32_bf16 v[20:23], v[60:63], v[156:159], v[20:23]
    v_mfma_f32_16x16x32_bf16 v[24:27], v[68:71], v[156:159], v[24:27]
    s_nop 4
    v_add_f32_dpp v29, v13, v12 row_ror:12 row_mask:0xf bank_mask:0xf
    v_add_f32_dpp v30, v18, v17 row_ror:12 row_mask:0xf bank_mask:0xf
    v_add_f32_dpp v31, v23, v22 row_ror:12 row_mask:0xf bank_mask:0xf
    v_add_f32_dpp v32, v24, v27 row_ror:12 row_mask:0xf bank_mask:0xf
    v_add_f32_dpp v29, v14, v29 row_ror:8 row_mask:0xf bank_mask:0xf
    v_add_f32_dpp v30, v19, v30 row_ror:8 row_mask:0xf bank_mask:0xf
    v_add_f32_dpp v31, v20, v31 row_ror:8 row_mask:0xf bank_mask:0xf
    v_add_f32_dpp v32, v25, v32 row_ror:8 row_mask:0xf bank_mask:0xf
    v_add_f32_dpp v28, v15, v29 row_ror:4 row_mask:0xf bank_mask:0x1
    s_nop 1
    v_add_f32_dpp v28, v16, v30 row_ror:4 row_mask:0xf bank_mask:0x2
    s_nop 1
    v_add_f32_dpp v28, v21, v31 row_ror:4 row_mask:0xf bank_mask:0x4
    s_nop 1
    v_add_f32_dpp v28, v26, v32 row_ror:4 row_mask:0xf bank_mask:0x8
    v_cvt_pk_bf16_f32 v28, 0, v28
    v_mul_f32 v28, 0x3db504f3, v28
    v_cvt_pk_bf16_f32 v28, 0, v28
    s_nop 1
    v_max_f32_dpp v29, v28, v28 quad_perm:[2,3,0,1] row_mask:0xf bank_mask:0xf
    s_nop 1
    v_max_f32_dpp v29, v29, v29 row_ror:4 row_mask:0xf bank_mask:0xf
    s_nop 1
    v_max_f32_dpp v29, v29, v29 row_ror:8 row_mask:0xf bank_mask:0xf
    v_mov_b32 v30, v29
    s_nop 1
    v_permlane16_swap_b32 v29, v30
    v_max_f32 v29, v29, v30
    v_mov_b32 v30, v29
    s_nop 1
    v_permlane32_swap_b32 v29, v30
    v_max_f32 v29, v29, v30
    v_mul_f32 v29, s60, v29
    v_and_b32 v29, 0xffffff00, v29
    v_fma_f32 v28, v28, s60, -v29
    v_exp_f32 v28, v28
    s_nop 0
    v_cvt_pk_bf16_f32 v30, v28, v28
    v_add_f32_dpp v28, v28, v28 quad_perm:[2,3,0,1] row_mask:0xf bank_mask:0xf
    s_nop 0
    v_mov_b32_dpp v31, v30 row_ror:4 row_mask:0xf bank_mask:0xf
    v_add_f32_dpp v28, v28, v28 row_ror:4 row_mask:0xf bank_mask:0xf
    v_mov_b32_dpp v32, v30 row_ror:8 row_mask:0xf bank_mask:0xf
    s_nop 0
    v_add_f32_dpp v28, v28, v28 row_ror:8 row_mask:0xf bank_mask:0xf
    v_mov_b32_dpp v33, v30 row_ror:12 row_mask:0xf bank_mask:0xf
    s_mov_b32 exec_lo, 0x30003
    s_mov_b32 exec_hi, 0x30003
    ds_write_b32 v163, v29 offset:16176
    ds_add_f32 v163, v28 offset:16180
    ds_add_u32 v164, v9 offset:16156
    s_mov_b64 exec, -1
    v_and_b32_dpp v40, v30, v5 quad_perm:[0,1,0,1] row_mask:0xf bank_mask:0xf
    v_and_b32_dpp v41, v31, v6 quad_perm:[0,1,0,1] row_mask:0xf bank_mask:0xf
    v_and_b32_dpp v42, v32, v7 quad_perm:[0,1,0,1] row_mask:0xf bank_mask:0xf
    v_and_b32_dpp v43, v33, v8 quad_perm:[0,1,0,1] row_mask:0xf bank_mask:0xf
    v_and_b32_dpp v44, v30, v5 quad_perm:[2,3,2,3] row_mask:0xf bank_mask:0xf
    v_and_b32_dpp v45, v31, v6 quad_perm:[2,3,2,3] row_mask:0xf bank_mask:0xf
    v_and_b32_dpp v46, v32, v7 quad_perm:[2,3,2,3] row_mask:0xf bank_mask:0xf
    v_and_b32_dpp v47, v33, v8 quad_perm:[2,3,2,3] row_mask:0xf bank_mask:0xf
    v_and_b32_dpp v48, v33, v5 quad_perm:[0,1,0,1] row_mask:0xf bank_mask:0xf
    v_and_b32_dpp v49, v30, v6 quad_perm:[0,1,0,1] row_mask:0xf bank_mask:0xf
    v_and_b32_dpp v50, v31, v7 quad_perm:[0,1,0,1] row_mask:0xf bank_mask:0xf
    v_and_b32_dpp v51, v32, v8 quad_perm:[0,1,0,1] row_mask:0xf bank_mask:0xf
    v_and_b32_dpp v52, v33, v5 quad_perm:[2,3,2,3] row_mask:0xf bank_mask:0xf
    v_and_b32_dpp v53, v30, v6 quad_perm:[2,3,2,3] row_mask:0xf bank_mask:0xf
    v_and_b32_dpp v54, v31, v7 quad_perm:[2,3,2,3] row_mask:0xf bank_mask:0xf
    v_and_b32_dpp v55, v32, v8 quad_perm:[2,3,2,3] row_mask:0xf bank_mask:0xf
    v_and_b32_dpp v56, v32, v5 quad_perm:[0,1,0,1] row_mask:0xf bank_mask:0xf
    v_and_b32_dpp v57, v33, v6 quad_perm:[0,1,0,1] row_mask:0xf bank_mask:0xf
    v_and_b32_dpp v58, v30, v7 quad_perm:[0,1,0,1] row_mask:0xf bank_mask:0xf
    v_and_b32_dpp v59, v31, v8 quad_perm:[0,1,0,1] row_mask:0xf bank_mask:0xf
    v_and_b32_dpp v60, v32, v5 quad_perm:[2,3,2,3] row_mask:0xf bank_mask:0xf
    v_and_b32_dpp v61, v33, v6 quad_perm:[2,3,2,3] row_mask:0xf bank_mask:0xf
    v_and_b32_dpp v62, v30, v7 quad_perm:[2,3,2,3] row_mask:0xf bank_mask:0xf
    v_and_b32_dpp v63, v31, v8 quad_perm:[2,3,2,3] row_mask:0xf bank_mask:0xf
    v_and_b32_dpp v64, v31, v5 quad_perm:[0,1,0,1] row_mask:0xf bank_mask:0xf
    v_and_b32_dpp v65, v32, v6 quad_perm:[0,1,0,1] row_mask:0xf bank_mask:0xf
    v_and_b32_dpp v66, v33, v7 quad_perm:[0,1,0,1] row_mask:0xf bank_mask:0xf
    v_and_b32_dpp v67, v30, v8 quad_perm:[0,1,0,1] row_mask:0xf bank_mask:0xf
    v_and_b32_dpp v68, v31, v5 quad_perm:[2,3,2,3] row_mask:0xf bank_mask:0xf
    v_and_b32_dpp v69, v32, v6 quad_perm:[2,3,2,3] row_mask:0xf bank_mask:0xf
    v_and_b32_dpp v70, v33, v7 quad_perm:[2,3,2,3] row_mask:0xf bank_mask:0xf
    v_and_b32_dpp v71, v30, v8 quad_perm:[2,3,2,3] row_mask:0xf bank_mask:0xf
    v_lshlrev_b32 v16, 4, v0
    s_lshl_b32 s43, s35, 10
    v_add_u32 v16, s43, v16
    s_cmp_eq_u32 s62, 1
    s_cbranch_scc1 QN_7
    s_cmp_eq_u32 s62, 2
    s_cbranch_scc1 QN_8
    s_cmp_eq_u32 s62, 3
    s_cbranch_scc1 QN_9
    s_cmp_eq_u32 s62, 4
    s_cbranch_scc1 QN_10
PV_4:
    s_waitcnt vmcnt(7)
    v_mfma_f32_16x16x32_bf16 v[12:15], v[40:43], v[72:75], 0
    s_waitcnt vmcnt(6)
    v_mfma_f32_16x16x32_bf16 v[12:15], v[44:47], v[76:79], v[12:15]
    s_waitcnt vmcnt(5)
    v_mfma_f32_16x16x32_bf16 v[12:15], v[48:51], v[80:83], v[12:15]
    s_waitcnt vmcnt(4)
    v_mfma_f32_16x16x32_bf16 v[12:15], v[52:55], v[84:87], v[12:15]
    s_waitcnt vmcnt(3)
    v_mfma_f32_16x16x32_bf16 v[12:15], v[56:59], v[88:91], v[12:15]
    s_waitcnt vmcnt(2)
    v_mfma_f32_16x16x32_bf16 v[12:15], v[60:63], v[92:95], v[12:15]
    s_waitcnt vmcnt(1)
    v_mfma_f32_16x16x32_bf16 v[12:15], v[64:67], v[96:99], v[12:15]
    s_waitcnt vmcnt(0)
    v_mfma_f32_16x16x32_bf16 v[12:15], v[68:71], v[100:103], v[12:15]
    s_nop 7
    ds_write_b128 v16, v[12:15] offset:6400
    s_waitcnt lgkmcnt(0)
    s_barrier
    s_branch JOIN_2
IDLE_1:
    s_mov_b64 exec, 0xff
    ds_add_u32 v164, v9 offset:16156
    s_mov_b64 exec, -1
    s_barrier
JOIN_2:
    s_cmp_ge_u32 s50, 18
    s_cbranch_scc1 L_FIN
    v_and_b32 v12, 7, v0
    v_lshlrev_b32 v13, 2, v12
    v_bfe_u32 v14, v0, 4, 1
    v_lshl_add_u32 v13, v14, 1, v13
    v_lshrrev_b32 v14, 5, v0
    v_add_u32 v13, v13, v14
    v_mul_u32_u24 v13, 48, v13
    v_lshrrev_b32 v14, 3, v0
    v_and_b32 v15, 31, v0
    v_mul_u32_u24 v20, 48, v15
    s_lshr_b32 s43, s50, 1
    s_lshl_b32 s43, s43, 7
    s_and_b32 s44, s50, 1
    s_lshl3_add_u32 s43, s44, s43
    v_bfe_u32 v16, v0, 2, 3
    v_and_b32 v15, 3, v0
    v_lshl_add_u32 v15, v16, 3, v15
    v_lshl_add_u32 v15, v15, 1, s43
    global_load_ushort v16, v15, s[4:5]
    global_load_ushort v17, v15, s[22:23]
    s_mul_i32 s43, s50, 18432
    s_lshl_b32 s44, s35, 11
    s_add_u32 s43, s43, s44
    s_add_u32 s43, s43, 786432
    v_lshl_add_u32 v18, v0, 4, s43
    s_lshl_b32 s43, s35, 2
    v_add_u32 v13, s43, v13
    s_mov_b64 s[52:53], -1
    s_mov_b64 s[54:55], -1
    s_mov_b32 s58, 0
    s_barrier
DPOLL_11:
    s_mov_b64 exec, s[52:53]
    global_load_dwordx4 v[136:139], v18, s[28:29] sc1
    s_mov_b64 exec, s[54:55]
    global_load_dwordx4 v[140:143], v18, s[28:29] offset:1024 sc1
    s_mov_b64 exec, s[52:53]
    s_cbranch_execz DSKIP_14
    s_waitcnt vmcnt(1)
    v_xor_b32 v136, s31, v136
    v_xor_b32 v137, s32, v137
    v_xor_b32 v138, s33, v138
    v_xor_b32 v139, s34, v139
    v_or3_b32 v19, v136, v137, v138
    v_or_b32 v19, v139, v19
    v_cmp_ne_u32_sdwa s[52:53], v19, 0 src0_sel:BYTE_0 src1_sel:DWORD
DSKIP_14:
    s_mov_b64 exec, s[54:55]
    s_nop 2
    s_cbranch_execz DSKIP_15
    s_waitcnt vmcnt(0)
    v_xor_b32 v140, s31, v140
    v_xor_b32 v141, s32, v141
    v_xor_b32 v142, s33, v142
    v_xor_b32 v143, s34, v143
    v_or3_b32 v19, v140, v141, v142
    v_or_b32 v19, v143, v19
    v_cmp_ne_u32_sdwa s[54:55], v19, 0 src0_sel:BYTE_0 src1_sel:DWORD
DSKIP_15:
    s_add_u32 s58, s58, 1
    s_cmp_ge_u32 s58, 60000
    s_nop 1
    s_cbranch_scc1 DDONE_12
    s_or_b64 vcc, s[52:53], s[54:55]
    s_cbranch_scc1 DPOLL_11
DDONE_12:
    s_mov_b64 exec, -1
    s_waitcnt vmcnt(0)
    v_pk_add_f32 v[136:137], v[136:137], v[140:141]
    v_pk_add_f32 v[138:139], v[138:139], v[142:143]
    s_nop 0
    v_add_f32_dpp v136, v136, v136 row_ror:8 row_mask:0xf bank_mask:0xf
    v_add_f32_dpp v137, v137, v137 row_ror:8 row_mask:0xf bank_mask:0xf
    v_add_f32_dpp v138, v138, v138 row_ror:8 row_mask:0xf bank_mask:0xf
    v_add_f32_dpp v139, v139, v139 row_ror:8 row_mask:0xf bank_mask:0xf
    v_permlane32_swap_b32 v136, v137
    s_nop 0
    v_permlane32_swap_b32 v138, v139
    v_add_f32 v136, v136, v137
    v_add_f32 v138, v138, v139
    s_nop 1
    v_permlane16_swap_b32 v136, v138
    v_add_f32 v19, v136, v138
    ds_write_b32 v13, v19 offset:16944
    v_lshlrev_b32 v16, 16, v16
    v_lshlrev_b32 v17, 16, v17
    s_waitcnt lgkmcnt(0)
    s_barrier
    s_cmp_lg_u32 s35, 1
    s_cbranch_scc1 L_FIN
    ds_read_b128 v[136:139], v20 offset:16944
    ds_read_b128 v[140:143], v20 offset:16960
    ds_read_b64 v[144:145], v20 offset:16976
    s_waitcnt lgkmcnt(0)
    v_pk_add_f32 v[136:137], v[136:137], v[140:141]
    v_pk_add_f32 v[138:139], v[138:139], v[142:143]
    v_cvt_pk_bf16_f32 v145, 0, v145
    v_pk_add_f32 v[136:137], v[136:137], v[138:139]
    v_add_f32 v16, v16, v145
    v_add_f32 v136, v136, v137
    v_cvt_pk_bf16_f32 v16, 0, v16
    v_add_f32 v136, v136, v144
    v_cvt_pk_bf16_f32 v136, 0, v136
    v_add_f32 v136, v136, v17
    v_cvt_pk_bf16_f32 v136, 0, v136
    v_add_f32 v136, v136, v16
    v_cvt_pk_bf16_f32 v136, v136, v136
    s_mov_b32 exec_lo, 0xffffffff
    s_mov_b32 exec_hi, 0x0
    global_store_short v15, v136, s[24:25]
    s_cmp_lg_u32 s50, 0
    s_cbranch_scc1 L_FIN
    s_mov_b64 exec, 1
    v_mov_b32 v12, 0
    v_mov_b32 v13, s30
    global_store_dword v12, v13, s[28:29] sc1
    s_endpgm
L_O:
    s_cmp_lg_u32 s35, 8
    s_cbranch_scc1 L_O8
    s_mov_b64 exec, 0xff
    ds_add_u32 v164, v9 offset:16156
    s_mov_b64 exec, -1
    s_branch L_FIN
L_O8:
    s_lshr_b32 s43, s35, 2
    s_and_b32 s44, s35, 3
    s_lshl_b32 s45, s36, 9
    s_lshl_b32 s46, s43, 8
    s_add_u32 s45, s45, s46
    s_lshl_b32 s46, s44, 1
    s_add_u32 s45, s45, s46
    s_mul_i32 s45, s45, 1152
    s_sub_u32 s46, s37, 18
    s_lshl_b32 s46, s46, 7
    s_add_u32 s45, s45, s46
    v_bfe_u32 v18, v0, 4, 1
    v_bfe_u32 v19, v0, 3, 1
    v_lshl_add_u32 v18, v18, 1, v19
    v_lshrrev_b32 v19, 5, v0
    v_lshl_add_u32 v18, v18, 6, v19
    v_mul_u32_u24 v18, 1152, v18
    v_and_b32 v19, 7, v0
    v_lshl_add_u32 v18, v19, 4, v18
    v_add_u32 v34, s45, v18
    s_lshl_b32 s45, s36, 1
    s_add_u32 s45, s45, s43
    s_lshl_b32 s45, s45, 14
    s_lshl_b32 s46, s44, 8
    s_add_u32 s45, s45, s46
    s_add_u32 s45, s45, 262144
    v_lshrrev_b32 v19, 4, v0
    v_and_b32 v21, 15, v0
    v_lshlrev_b32 v20, 12, v19
    v_lshl_add_u32 v20, v21, 4, v20
    v_add_u32 v35, s45, v20
    s_lshl_b32 s45, s43, 7
    v_lshl_add_u32 v36, v19, 5, s45
    s_cmp_ge_u32 s35, s97
    s_cbranch_scc1 IDLE_16
    s_mov_b32 s62, 0
    s_waitcnt vmcnt(5)
    global_load_dwordx4 v[56:59], v10, s[6:7] nt
    v_add_u32 v10, s63, v10
    s_waitcnt vmcnt(5)
    global_load_dwordx4 v[60:63], v10, s[6:7] nt
    v_add_u32 v10, s63, v10
    s_waitcnt vmcnt(5)
    global_load_dwordx4 v[64:67], v10, s[6:7] nt
    v_add_u32 v10, s63, v10
    s_waitcnt vmcnt(5)
    global_load_dwordx4 v[68:71], v10, s[6:7] nt
    s_waitcnt vmcnt(5)
    global_load_dwordx4 v[72:75], v11, s[8:9] nt
    v_add_u32 v11, s63, v11
    s_waitcnt vmcnt(5)
    global_load_dwordx4 v[76:79], v11, s[8:9] nt
    v_add_u32 v11, s63, v11
    s_waitcnt vmcnt(5)
    global_load_dwordx4 v[80:83], v11, s[8:9] nt
    v_add_u32 v11, s63, v11
    s_waitcnt vmcnt(5)
    global_load_dwordx4 v[84:87], v11, s[8:9] nt
    v_add_u32 v11, s63, v11
    s_waitcnt vmcnt(5)
    global_load_dwordx4 v[88:91], v11, s[8:9] nt
    v_add_u32 v11, s63, v11
    s_waitcnt vmcnt(5)
    global_load_dwordx4 v[92:95], v11, s[8:9] nt
    v_add_u32 v11, s63, v11
    ds_read_b32 v160, v164 offset:16160
    ds_read_b128 v[152:155], v166
    ds_read_b128 v[156:159], v165
    s_waitcnt lgkmcnt(2)
    v_readfirstlane_b32 s61, v160
    s_nop 0
    s_cmp_eq_u32 s61, 0
    s_nop 1
    s_cbranch_scc1 QN_22
    s_mov_b32 s62, 1
    s_branch QS_18
QN_22:
    s_waitcnt vmcnt(5)
    global_load_dwordx4 v[96:99], v11, s[8:9] nt
    v_add_u32 v11, s63, v11
    s_cmp_lg_u32 s62, 0
    s_cbranch_scc1 QN_23
    ds_read_b32 v160, v164 offset:16160
    ds_read_b128 v[152:155], v166
    ds_read_b128 v[156:159], v165
    s_waitcnt lgkmcnt(2)
    v_readfirstlane_b32 s61, v160
    s_nop 0
    s_cmp_eq_u32 s61, 0
    s_nop 1
    s_cbranch_scc1 QN_23
    s_mov_b32 s62, 2
    s_branch QS_18
QN_23:
    s_waitcnt vmcnt(5)
    global_load_dwordx4 v[100:103], v11, s[8:9] nt
    s_cmp_lg_u32 s62, 0
    s_cbranch_scc1 QN_24
    ds_read_b32 v160, v164 offset:16160
    ds_read_b128 v[152:155], v166
    ds_read_b128 v[156:159], v165
    s_waitcnt lgkmcnt(2)
    v_readfirstlane_b32 s61, v160
    s_nop 0
    s_cmp_eq_u32 s61, 0
    s_nop 1
    s_cbranch_scc1 QN_24
    s_mov_b32 s62, 3
    s_branch QS_18
QN_24:
    s_waitcnt vmcnt(5)
    global_load_dwordx4 v[104:107], v34, s[12:13] nt
    v_add_u32 v34, 9216, v34
    s_cmp_lg_u32 s62, 0
    s_cbranch_scc1 QN_25
    ds_read_b32 v160, v164 offset:16160
    ds_read_b128 v[152:155], v166
    ds_read_b128 v[156:159], v165
    s_waitcnt lgkmcnt(2)
    v_readfirstlane_b32 s61, v160
    s_nop 0
    s_cmp_eq_u32 s61, 0
    s_nop 1
    s_cbranch_scc1 QN_25
    s_mov_b32 s62, 4
    s_branch QS_18
QN_25:
    s_waitcnt vmcnt(5)
    global_load_dwordx4 v[108:111], v34, s[12:13] nt
    v_add_u32 v34, 9216, v34
    s_cmp_lg_u32 s62, 0
    s_cbranch_scc1 QN_26
    ds_read_b32 v160, v164 offset:16160
    ds_read_b128 v[152:155], v166
    ds_read_b128 v[156:159], v165
    s_waitcnt lgkmcnt(2)
    v_readfirstlane_b32 s61, v160
    s_nop 0
    s_cmp_eq_u32 s61, 0
    s_nop 1
    s_cbranch_scc1 QN_26
    s_mov_b32 s62, 5
    s_branch QS_18
QN_26:
    s_waitcnt vmcnt(5)
    global_load_dwordx4 v[112:115], v34, s[12:13] nt
    v_add_u32 v34, 9216, v34
    s_cmp_lg_u32 s62, 0
    s_cbranch_scc1 QN_27
    ds_read_b32 v160, v164 offset:16160
    ds_read_b128 v[152:155], v166
    ds_read_b128 v[156:159], v165
    s_waitcnt lgkmcnt(2)
    v_readfirstlane_b32 s61, v160
    s_nop 0
    s_cmp_eq_u32 s61, 0
    s_nop 1
    s_cbranch_scc1 QN_27
    s_mov_b32 s62, 6
    s_branch QS_18
QN_27:
    s_waitcnt vmcnt(5)
    global_load_dwordx4 v[116:119], v34, s[12:13] nt
    v_add_u32 v34, 9216, v34
    s_cmp_lg_u32 s62, 0
    s_cbranch_scc1 QN_28
    ds_read_b32 v160, v164 offset:16160
    ds_read_b128 v[152:155], v166
    ds_read_b128 v[156:159], v165
    s_waitcnt lgkmcnt(2)
    v_readfirstlane_b32 s61, v160
    s_nop 0
    s_cmp_eq_u32 s61, 0
    s_nop 1
    s_cbranch_scc1 QN_28
    s_mov_b32 s62, 7
    s_branch QS_18
QN_28:
    s_waitcnt vmcnt(5)
    global_load_dwordx4 v[120:123], v34, s[12:13] nt
    v_add_u32 v34, 9216, v34
    s_cmp_lg_u32 s62, 0
    s_cbranch_scc1 QN_29
    ds_read_b32 v160, v164 offset:16160
    ds_read_b128 v[152:155], v166
    ds_read_b128 v[156:159], v165
    s_waitcnt lgkmcnt(2)
    v_readfirstlane_b32 s61, v160
    s_nop 0
    s_cmp_eq_u32 s61, 0
    s_nop 1
    s_cbranch_scc1 QN_29
    s_mov_b32 s62, 8
    s_branch QS_18
QN_29:
    s_waitcnt vmcnt(5)
    global_load_dwordx4 v[124:127], v34, s[12:13] nt
    v_add_u32 v34, 9216, v34
    s_cmp_lg_u32 s62, 0
    s_cbranch_scc1 QN_30
    ds_read_b32 v160, v164 offset:16160
    ds_read_b128 v[152:155], v166
    ds_read_b128 v[156:159], v165
    s_waitcnt lgkmcnt(2)
    v_readfirstlane_b32 s61, v160
    s_nop 0
    s_cmp_eq_u32 s61, 0
    s_nop 1
    s_cbranch_scc1 QN_30
    s_mov_b32 s62, 9
    s_branch QS_18
QN_30:
    s_waitcnt vmcnt(5)
    global_load_dwordx4 v[128:131], v34, s[12:13] nt
    v_add_u32 v34, 9216, v34
    s_cmp_lg_u32 s62, 0
    s_cbranch_scc1 QN_31
    ds_read_b32 v160, v164 offset:16160
    ds_read_b128 v[152:155], v166
    ds_read_b128 v[156:159], v165
    s_waitcnt lgkmcnt(2)
    v_readfirstlane_b32 s61, v160
    s_nop 0
    s_cmp_eq_u32 s61, 0
    s_nop 1
    s_cbranch_scc1 QN_31
    s_mov_b32 s62, 10
    s_branch QS_18
QN_31:
    s_waitcnt vmcnt(5)
    global_load_dwordx4 v[132:135], v34, s[12:13] nt
    s_cmp_lg_u32 s62, 0
    s_cbranch_scc1 PV_19
    s_mov_b32 s58, 0
QSPIN_20:
    ds_read_b32 v160, v164 offset:16160
    ds_read_b128 v[152:155], v166
    ds_read_b128 v[156:159], v165
    s_add_u32 s58, s58, 1
    s_waitcnt lgkmcnt(2)
    v_readfirstlane_b32 s61, v160
    s_cmp_ge_u32 s58, 480000
    s_nop 2
    s_cbranch_scc1 QS_18
    s_cmp_eq_u32 s61, 0
    s_cbranch_scc1 QSPIN_20
QS_18:
    s_waitcnt lgkmcnt(1)
    v_mfma_f32_16x16x32_bf16 v[12:15], v[40:43], v[152:155], 0
    v_mfma_f32_16x16x32_bf16 v[16:19], v[48:51], v[152:155], 0
    v_mfma_f32_16x16x32_bf16 v[20:23], v[56:59], v[152:155], 0
    v_mfma_f32_16x16x32_bf16 v[24:27], v[64:67], v[152:155], 0
    s_waitcnt lgkmcnt(0)
    v_mfma_f32_16x16x32_bf16 v[12:15], v[44:47], v[156:159], v[12:15]
    v_mfma_f32_16x16x32_bf16 v[16:19], v[52:55], v[156:159], v[16:19]
    v_mfma_f32_16x16x32_bf16 v[20:23], v[60:63], v[156:159], v[20:23]
    v_mfma_f32_16x16x32_bf16 v[24:27], v[68:71], v[156:159], v[24:27]
    s_nop 4
    v_add_f32_dpp v29, v13, v12 row_ror:12 row_mask:0xf bank_mask:0xf
    v_add_f32_dpp v30, v18, v17 row_ror:12 row_mask:0xf bank_mask:0xf
    v_add_f32_dpp v31, v23, v22 row_ror:12 row_mask:0xf bank_mask:0xf
    v_add_f32_dpp v32, v24, v27 row_ror:12 row_mask:0xf bank_mask:0xf
    v_add_f32_dpp v29, v14, v29 row_ror:8 row_mask:0xf bank_mask:0xf
    v_add_f32_dpp v30, v19, v30 row_ror:8 row_mask:0xf bank_mask:0xf
    v_add_f32_dpp v31, v20, v31 row_ror:8 row_mask:0xf bank_mask:0xf
    v_add_f32_dpp v32, v25, v32 row_ror:8 row_mask:0xf bank_mask:0xf
    v_add_f32_dpp v28, v15, v29 row_ror:4 row_mask:0xf bank_mask:0x1
    s_nop 1
    v_add_f32_dpp v28, v16, v30 row_ror:4 row_mask:0xf bank_mask:0x2
    s_nop 1
    v_add_f32_dpp v28, v21, v31 row_ror:4 row_mask:0xf bank_mask:0x4
    s_nop 1
    v_add_f32_dpp v28, v26, v32 row_ror:4 row_mask:0xf bank_mask:0x8
    v_cvt_pk_bf16_f32 v28, 0, v28
    v_mul_f32 v28, 0x3db504f3, v28
    v_cvt_pk_bf16_f32 v28, 0, v28
    s_nop 1
    v_max_f32_dpp v29, v28, v28 quad_perm:[2,3,0,1] row_mask:0xf bank_mask:0xf
    s_nop 1
    v_max_f32_dpp v29, v29, v29 row_ror:4 row_mask:0xf bank_mask:0xf
    s_nop 1
    v_max_f32_dpp v29, v29, v29 row_ror:8 row_mask:0xf bank_mask:0xf
    v_mov_b32 v30, v29
    s_nop 1
    v_permlane16_swap_b32 v29, v30
    v_max_f32 v29, v29, v30
    v_mov_b32 v30, v29
    s_nop 1
    v_permlane32_swap_b32 v29, v30
    v_max_f32 v29, v29, v30
    v_mul_f32 v29, s60, v29
    v_and_b32 v29, 0xffffff00, v29
    v_fma_f32 v28, v28, s60, -v29
    v_exp_f32 v28, v28
    s_nop 0
    v_cvt_pk_bf16_f32 v30, v28, v28
    v_add_f32_dpp v28, v28, v28 quad_perm:[2,3,0,1] row_mask:0xf bank_mask:0xf
    s_nop 0
    v_mov_b32_dpp v31, v30 row_ror:4 row_mask:0xf bank_mask:0xf
    v_add_f32_dpp v28, v28, v28 row_ror:4 row_mask:0xf bank_mask:0xf
    v_mov_b32_dpp v32, v30 row_ror:8 row_mask:0xf bank_mask:0xf
    s_nop 0
    v_add_f32_dpp v28, v28, v28 row_ror:8 row_mask:0xf bank_mask:0xf
    v_mov_b32_dpp v33, v30 row_ror:12 row_mask:0xf bank_mask:0xf
    s_mov_b32 exec_lo, 0x30003
    s_mov_b32 exec_hi, 0x30003
    ds_write_b32 v163, v29 offset:16176
    ds_add_f32 v163, v28 offset:16180
    ds_add_u32 v164, v9 offset:16156
    s_mov_b64 exec, -1
    v_and_b32_dpp v40, v30, v5 quad_perm:[0,1,0,1] row_mask:0xf bank_mask:0xf
    v_and_b32_dpp v41, v31, v6 quad_perm:[0,1,0,1] row_mask:0xf bank_mask:0xf
    v_and_b32_dpp v42, v32, v7 quad_perm:[0,1,0,1] row_mask:0xf bank_mask:0xf
    v_and_b32_dpp v43, v33, v8 quad_perm:[0,1,0,1] row_mask:0xf bank_mask:0xf
    v_and_b32_dpp v44, v30, v5 quad_perm:[2,3,2,3] row_mask:0xf bank_mask:0xf
    v_and_b32_dpp v45, v31, v6 quad_perm:[2,3,2,3] row_mask:0xf bank_mask:0xf
    v_and_b32_dpp v46, v32, v7 quad_perm:[2,3,2,3] row_mask:0xf bank_mask:0xf
    v_and_b32_dpp v47, v33, v8 quad_perm:[2,3,2,3] row_mask:0xf bank_mask:0xf
    v_and_b32_dpp v48, v33, v5 quad_perm:[0,1,0,1] row_mask:0xf bank_mask:0xf
    v_and_b32_dpp v49, v30, v6 quad_perm:[0,1,0,1] row_mask:0xf bank_mask:0xf
    v_and_b32_dpp v50, v31, v7 quad_perm:[0,1,0,1] row_mask:0xf bank_mask:0xf
    v_and_b32_dpp v51, v32, v8 quad_perm:[0,1,0,1] row_mask:0xf bank_mask:0xf
    v_and_b32_dpp v52, v33, v5 quad_perm:[2,3,2,3] row_mask:0xf bank_mask:0xf
    v_and_b32_dpp v53, v30, v6 quad_perm:[2,3,2,3] row_mask:0xf bank_mask:0xf
    v_and_b32_dpp v54, v31, v7 quad_perm:[2,3,2,3] row_mask:0xf bank_mask:0xf
    v_and_b32_dpp v55, v32, v8 quad_perm:[2,3,2,3] row_mask:0xf bank_mask:0xf
    v_and_b32_dpp v56, v32, v5 quad_perm:[0,1,0,1] row_mask:0xf bank_mask:0xf
    v_and_b32_dpp v57, v33, v6 quad_perm:[0,1,0,1] row_mask:0xf bank_mask:0xf
    v_and_b32_dpp v58, v30, v7 quad_perm:[0,1,0,1] row_mask:0xf bank_mask:0xf
    v_and_b32_dpp v59, v31, v8 quad_perm:[0,1,0,1] row_mask:0xf bank_mask:0xf
    v_and_b32_dpp v60, v32, v5 quad_perm:[2,3,2,3] row_mask:0xf bank_mask:0xf
    v_and_b32_dpp v61, v33, v6 quad_perm:[2,3,2,3] row_mask:0xf bank_mask:0xf
    v_and_b32_dpp v62, v30, v7 quad_perm:[2,3,2,3] row_mask:0xf bank_mask:0xf
    v_and_b32_dpp v63, v31, v8 quad_perm:[2,3,2,3] row_mask:0xf bank_mask:0xf
    v_and_b32_dpp v64, v31, v5 quad_perm:[0,1,0,1] row_mask:0xf bank_mask:0xf
    v_and_b32_dpp v65, v32, v6 quad_perm:[0,1,0,1] row_mask:0xf bank_mask:0xf
    v_and_b32_dpp v66, v33, v7 quad_perm:[0,1,0,1] row_mask:0xf bank_mask:0xf
    v_and_b32_dpp v67, v30, v8 quad_perm:[0,1,0,1] row_mask:0xf bank_mask:0xf
    v_and_b32_dpp v68, v31, v5 quad_perm:[2,3,2,3] row_mask:0xf bank_mask:0xf
    v_and_b32_dpp v69, v32, v6 quad_perm:[2,3,2,3] row_mask:0xf bank_mask:0xf
    v_and_b32_dpp v70, v33, v7 quad_perm:[2,3,2,3] row_mask:0xf bank_mask:0xf
    v_and_b32_dpp v71, v30, v8 quad_perm:[2,3,2,3] row_mask:0xf bank_mask:0xf
    v_lshlrev_b32 v16, 4, v0
    s_lshl_b32 s43, s35, 10
    v_add_u32 v16, s43, v16
    s_cmp_eq_u32 s62, 1
    s_cbranch_scc1 QN_22
    s_cmp_eq_u32 s62, 2
    s_cbranch_scc1 QN_23
    s_cmp_eq_u32 s62, 3
    s_cbranch_scc1 QN_24
    s_cmp_eq_u32 s62, 4
    s_cbranch_scc1 QN_25
    s_cmp_eq_u32 s62, 5
    s_cbranch_scc1 QN_26
    s_cmp_eq_u32 s62, 6
    s_cbranch_scc1 QN_27
    s_cmp_eq_u32 s62, 7
    s_cbranch_scc1 QN_28
    s_cmp_eq_u32 s62, 8
    s_cbranch_scc1 QN_29
    s_cmp_eq_u32 s62, 9
    s_cbranch_scc1 QN_30
    s_cmp_eq_u32 s62, 10
    s_cbranch_scc1 QN_31
PV_19:
    s_waitcnt vmcnt(15)
    v_mfma_f32_16x16x32_bf16 v[12:15], v[40:43], v[72:75], 0
    s_waitcnt vmcnt(14)
    v_mfma_f32_16x16x32_bf16 v[12:15], v[44:47], v[76:79], v[12:15]
    s_waitcnt vmcnt(13)
    v_mfma_f32_16x16x32_bf16 v[12:15], v[48:51], v[80:83], v[12:15]
    s_waitcnt vmcnt(12)
    v_mfma_f32_16x16x32_bf16 v[12:15], v[52:55], v[84:87], v[12:15]
    s_waitcnt vmcnt(11)
    v_mfma_f32_16x16x32_bf16 v[12:15], v[56:59], v[88:91], v[12:15]
    s_waitcnt vmcnt(10)
    v_mfma_f32_16x16x32_bf16 v[12:15], v[60:63], v[92:95], v[12:15]
    s_waitcnt vmcnt(9)
    v_mfma_f32_16x16x32_bf16 v[12:15], v[64:67], v[96:99], v[12:15]
    s_waitcnt vmcnt(8)
    v_mfma_f32_16x16x32_bf16 v[12:15], v[68:71], v[100:103], v[12:15]
    s_nop 7
    ds_write_b128 v16, v[12:15] offset:6400
    s_waitcnt lgkmcnt(0)
    s_barrier
    s_branch JOIN_17
IDLE_16:
    s_mov_b64 exec, 0xff
    ds_add_u32 v164, v9 offset:16156
    s_mov_b64 exec, -1
    global_load_dwordx4 v[104:107], v34, s[12:13] nt
    v_add_u32 v34, 9216, v34
    global_load_dwordx4 v[108:111], v34, s[12:13] nt
    v_add_u32 v34, 9216, v34
    global_load_dwordx4 v[112:115], v34, s[12:13] nt
    v_add_u32 v34, 9216, v34
    global_load_dwordx4 v[116:119], v34, s[12:13] nt
    v_add_u32 v34, 9216, v34
    global_load_dwordx4 v[120:123], v34, s[12:13] nt
    v_add_u32 v34, 9216, v34
    global_load_dwordx4 v[124:127], v34, s[12:13] nt
    v_add_u32 v34, 9216, v34
    s_waitcnt vmcnt(5)
    global_load_dwordx4 v[128:131], v34, s[12:13] nt
    v_add_u32 v34, 9216, v34
    s_waitcnt vmcnt(5)
    global_load_dwordx4 v[132:135], v34, s[12:13] nt
    s_barrier
JOIN_17:
    s_mov_b64 s[50:51], -1
    s_mov_b64 s[52:53], -1
    s_mov_b64 s[54:55], -1
    s_mov_b64 s[56:57], -1
    s_mov_b32 s58, 0
    s_barrier
    global_load_dwordx4 v[136:139], v35, s[28:29] offset:0 sc1
    global_load_dwordx4 v[140:143], v35, s[28:29] offset:1024 sc1
    global_load_dwordx4 v[144:147], v35, s[28:29] offset:2048 sc1
    global_load_dwordx4 v[148:151], v35, s[28:29] offset:3072 sc1
    s_barrier
    ds_read_b128 v[72:75], v36 offset:16688
    ds_read_b128 v[76:79], v36 offset:16704
    s_branch DCHK_34
DPOLL_32:
    s_mov_b64 exec, s[50:51]
    global_load_dwordx4 v[136:139], v35, s[28:29] offset:0 sc1
    s_mov_b64 exec, s[52:53]
    global_load_dwordx4 v[140:143], v35, s[28:29] offset:1024 sc1
    s_mov_b64 exec, s[54:55]
    global_load_dwordx4 v[144:147], v35, s[28:29] offset:2048 sc1
    s_mov_b64 exec, s[56:57]
    global_load_dwordx4 v[148:151], v35, s[28:29] offset:3072 sc1
DCHK_34:
    s_mov_b64 exec, s[50:51]
    s_cbranch_execz DSKIP_35
    s_waitcnt vmcnt(3)
    v_xor_b32 v136, s31, v136
    v_xor_b32 v137, s32, v137
    v_xor_b32 v138, s33, v138
    v_xor_b32 v139, s34, v139
    v_or3_b32 v20, v136, v137, v138
    v_or_b32 v20, v139, v20
    v_cmp_ne_u32_sdwa s[50:51], v20, 0 src0_sel:BYTE_0 src1_sel:DWORD
DSKIP_35:
    s_mov_b64 exec, s[52:53]
    s_nop 2
    s_cbranch_execz DSKIP_36
    s_waitcnt vmcnt(2)
    v_xor_b32 v140, s31, v140
    v_xor_b32 v141, s32, v141
    v_xor_b32 v142, s33, v142
    v_xor_b32 v143, s34, v143
    v_or3_b32 v20, v140, v141, v142
    v_or_b32 v20, v143, v20
    v_cmp_ne_u32_sdwa s[52:53], v20, 0 src0_sel:BYTE_0 src1_sel:DWORD
DSKIP_36:
    s_mov_b64 exec, s[54:55]
    s_nop 2
    s_cbranch_execz DSKIP_37
    s_waitcnt vmcnt(1)
    v_xor_b32 v144, s31, v144
    v_xor_b32 v145, s32, v145
    v_xor_b32 v146, s33, v146
    v_xor_b32 v147, s34, v147
    v_or3_b32 v20, v144, v145, v146
    v_or_b32 v20, v147, v20
    v_cmp_ne_u32_sdwa s[54:55], v20, 0 src0_sel:BYTE_0 src1_sel:DWORD
DSKIP_37:
    s_mov_b64 exec, s[56:57]
    s_nop 2
    s_cbranch_execz DSKIP_38
    s_waitcnt vmcnt(0)
    v_xor_b32 v148, s31, v148
    v_xor_b32 v149, s32, v149
    v_xor_b32 v150, s33, v150
    v_xor_b32 v151, s34, v151
    v_or3_b32 v20, v148, v149, v150
    v_or_b32 v20, v151, v20
    v_cmp_ne_u32_sdwa s[56:57], v20, 0 src0_sel:BYTE_0 src1_sel:DWORD
DSKIP_38:
    s_add_u32 s58, s58, 1
    s_cmp_ge_u32 s58, 60000
    s_nop 1
    s_cbranch_scc1 DDONE_33
    s_or_b64 vcc, s[50:51], s[52:53]
    s_or_b64 vcc, vcc, s[54:55]
    s_or_b64 vcc, vcc, s[56:57]
    s_cbranch_scc1 DPOLL_32
DDONE_33:
    s_mov_b64 exec, -1
    s_waitcnt vmcnt(0)
    s_waitcnt lgkmcnt(0)
    v_pk_mul_f32 v[20:21], v[136:137], v[72:73]
    v_pk_mul_f32 v[22:23], v[138:139], v[72:73]
    v_pk_fma_f32 v[20:21], v[140:141], v[74:75], v[20:21]
    v_pk_fma_f32 v[22:23], v[142:143], v[74:75], v[22:23]
    v_pk_fma_f32 v[20:21], v[144:145], v[76:77], v[20:21]
    v_pk_fma_f32 v[22:23], v[146:147], v[76:77], v[22:23]
    v_pk_fma_f32 v[20:21], v[148:149], v[78:79], v[20:21]
    v_pk_fma_f32 v[22:23], v[150:151], v[78:79], v[22:23]
    s_nop 1
    v_permlane32_swap_b32 v20, v22
    v_permlane32_swap_b32 v21, v23
    v_add_f32 v20, v20, v22
    v_add_f32 v21, v21, v23
    s_nop 1
    v_permlane16_swap_b32 v20, v21
    v_add_f32 v20, v20, v21
    v_cvt_pk_bf16_f32 v20, v20, v20
    s_nop 1
    v_mov_b32_dpp v21, v20 row_half_mirror row_mask:0xf bank_mask:0xf
    v_and_b32_dpp v40, v20, v1 quad_perm:[0,0,0,0] row_mask:0xf bank_mask:0xf
    v_and_b32_dpp v41, v20, v2 quad_perm:[0,0,0,0] row_mask:0xf bank_mask:0xf
    v_and_b32_dpp v42, v21, v3 quad_perm:[3,3,3,3] row_mask:0xf bank_mask:0xf
    v_and_b32_dpp v43, v21, v4 quad_perm:[3,3,3,3] row_mask:0xf bank_mask:0xf
    v_and_b32_dpp v44, v20, v1 quad_perm:[1,1,1,1] row_mask:0xf bank_mask:0xf
    v_and_b32_dpp v45, v20, v2 quad_perm:[1,1,1,1] row_mask:0xf bank_mask:0xf
    v_and_b32_dpp v46, v21, v3 quad_perm:[2,2,2,2] row_mask:0xf bank_mask:0xf
    v_and_b32_dpp v47, v21, v4 quad_perm:[2,2,2,2] row_mask:0xf bank_mask:0xf
    v_mfma_f32_16x16x32_bf16 v[12:15], v[40:43], v[104:107], 0
    v_and_b32_dpp v48, v20, v1 quad_perm:[2,2,2,2] row_mask:0xf bank_mask:0xf
    v_and_b32_dpp v49, v20, v2 quad_perm:[2,2,2,2] row_mask:0xf bank_mask:0xf
    v_and_b32_dpp v50, v21, v3 quad_perm:[1,1,1,1] row_mask:0xf bank_mask:0xf
    v_and_b32_dpp v51, v21, v4 quad_perm:[1,1,1,1] row_mask:0xf bank_mask:0xf
    v_mfma_f32_16x16x32_bf16 v[12:15], v[44:47], v[108:111], v[12:15]
    v_and_b32_dpp v52, v20, v1 quad_perm:[3,3,3,3] row_mask:0xf bank_mask:0xf
    v_and_b32_dpp v53, v20, v2 quad_perm:[3,3,3,3] row_mask:0xf bank_mask:0xf
    v_and_b32_dpp v54, v21, v3 quad_perm:[0,0,0,0] row_mask:0xf bank_mask:0xf
    v_and_b32_dpp v55, v21, v4 quad_perm:[0,0,0,0] row_mask:0xf bank_mask:0xf
    v_mfma_f32_16x16x32_bf16 v[12:15], v[48:51], v[112:115], v[12:15]
    v_and_b32_dpp v58, v20, v3 quad_perm:[0,0,0,0] row_mask:0xf bank_mask:0xf
    v_and_b32_dpp v59, v20, v4 quad_perm:[0,0,0,0] row_mask:0xf bank_mask:0xf
    v_and_b32_dpp v56, v21, v1 quad_perm:[3,3,3,3] row_mask:0xf bank_mask:0xf
    v_and_b32_dpp v57, v21, v2 quad_perm:[3,3,3,3] row_mask:0xf bank_mask:0xf
    v_mfma_f32_16x16x32_bf16 v[12:15], v[52:55], v[116:119], v[12:15]
    v_and_b32_dpp v62, v20, v3 quad_perm:[1,1,1,1] row_mask:0xf bank_mask:0xf
    v_and_b32_dpp v63, v20, v4 quad_perm:[1,1,1,1] row_mask:0xf bank_mask:0xf
    v_and_b32_dpp v60, v21, v1 quad_perm:[2,2,2,2] row_mask:0xf bank_mask:0xf
    v_and_b32_dpp v61, v21, v2 quad_perm:[2,2,2,2] row_mask:0xf bank_mask:0xf
    v_mfma_f32_16x16x32_bf16 v[12:15], v[56:59], v[120:123], v[12:15]
    v_and_b32_dpp v66, v20, v3 quad_perm:[2,2,2,2] row_mask:0xf bank_mask:0xf
    v_and_b32_dpp v67, v20, v4 quad_perm:[2,2,2,2] row_mask:0xf bank_mask:0xf
    v_and_b32_dpp v64, v21, v1 quad_perm:[1,1,1,1] row_mask:0xf bank_mask:0xf
    v_and_b32_dpp v65, v21, v2 quad_perm:[1,1,1,1] row_mask:0xf bank_mask:0xf
    v_mfma_f32_16x16x32_bf16 v[12:15], v[60:63], v[124:127], v[12:15]
    v_and_b32_dpp v70, v20, v3 quad_perm:[3,3,3,3] row_mask:0xf bank_mask:0xf
    v_and_b32_dpp v71, v20, v4 quad_perm:[3,3,3,3] row_mask:0xf bank_mask:0xf
    v_and_b32_dpp v68, v21, v1 quad_perm:[0,0,0,0] row_mask:0xf bank_mask:0xf
    v_and_b32_dpp v69, v21, v2 quad_perm:[0,0,0,0] row_mask:0xf bank_mask:0xf
    v_mfma_f32_16x16x32_bf16 v[12:15], v[64:67], v[128:131], v[12:15]
    s_nop 0
    v_mfma_f32_16x16x32_bf16 v[12:15], v[68:71], v[132:135], v[12:15]
    s_mov_b32 exec_lo, 0xff00ff
    s_mov_b32 exec_hi, 0xff00ff00
    s_nop 5
    ds_write_b128 v167, v[12:15] offset:0
    s_waitcnt lgkmcnt(0)
    s_barrier
    s_endpgm
L_M:
    s_mul_i32 s50, s36, 18
    s_add_u32 s50, s50, s37
    s_and_b32 s51, s2, 7
    s_mul_i32 s51, s51, 18432
    s_mul_i32 s43, s35, 589824
    s_lshl_b32 s44, s50, 6
    s_add_u32 s43, s43, s44
    v_bfe_u32 v24, v0, 2, 2
    v_lshrrev_b32 v25, 4, v0
    v_lshl_add_u32 v24, v24, 4, v25
    v_and_b32 v26, 3, v0
    v_lshl_add_u32 v27, v26, 4, s43
    v_mov_b32 v28, 9216
    v_mad_u32_u24 v34, v24, v28, v27
    s_mul_i32 s43, s50, 36864
    s_lshl_b32 s45, s35, 7
    s_add_u32 s43, s43, s45
    v_lshrrev_b32 v24, 3, v0
    v_mul_u32_u24 v27, 4608, v24
    v_and_b32 v28, 7, v0
    v_lshl_add_u32 v27, v28, 4, v27
    v_add_u32 v35, s43, v27
    v_lshl_add_u32 v24, v24, 2, v26
    v_lshl_add_u32 v39, v24, 1, s44
    v_and_b32 v24, 15, v0
    v_lshl_add_u32 v26, v24, 2, v25
    v_lshl_add_u32 v38, v26, 1, s45
    s_lshl_b32 s43, s35, 11
    s_add_u32 s43, s43, s51
    s_add_u32 s43, s43, 524288
    v_lshl_add_u32 v37, v0, 4, s43
    s_cmp_ge_u32 s35, s97
    s_cbranch_scc1 IDLE_39
    s_mov_b32 s62, 0
    s_waitcnt vmcnt(3)
    global_load_dwordx4 v[56:59], v10, s[6:7] nt
    v_add_u32 v10, s63, v10
    s_waitcnt vmcnt(3)
    global_load_dwordx4 v[60:63], v10, s[6:7] nt
    v_add_u32 v10, s63, v10
    s_waitcnt vmcnt(3)
    global_load_dwordx4 v[64:67], v10, s[6:7] nt
    v_add_u32 v10, s63, v10
    s_waitcnt vmcnt(3)
    global_load_dwordx4 v[68:71], v10, s[6:7] nt
    s_waitcnt vmcnt(3)
    global_load_dwordx4 v[72:75], v11, s[8:9] nt
    v_add_u32 v11, s63, v11
    s_waitcnt vmcnt(3)
    global_load_dwordx4 v[76:79], v11, s[8:9] nt
    v_add_u32 v11, s63, v11
    s_waitcnt vmcnt(3)
    global_load_dwordx4 v[80:83], v11, s[8:9] nt
    v_add_u32 v11, s63, v11
    s_waitcnt vmcnt(3)
    global_load_dwordx4 v[84:87], v11, s[8:9] nt
    v_add_u32 v11, s63, v11
    ds_read_b32 v160, v164 offset:16160
    ds_read_b128 v[152:155], v166
    ds_read_b128 v[156:159], v165
    s_waitcnt lgkmcnt(2)
    v_readfirstlane_b32 s61, v160
    s_nop 0
    s_cmp_eq_u32 s61, 0
    s_nop 1
    s_cbranch_scc1 QN_45
    s_mov_b32 s62, 1
    s_branch QS_41
QN_45:
    s_waitcnt vmcnt(3)
    global_load_dwordx4 v[88:91], v11, s[8:9] nt
    v_add_u32 v11, s63, v11
    s_cmp_lg_u32 s62, 0
    s_cbranch_scc1 QN_46
    ds_read_b32 v160, v164 offset:16160
    ds_read_b128 v[152:155], v166
    ds_read_b128 v[156:159], v165
    s_waitcnt lgkmcnt(2)
    v_readfirstlane_b32 s61, v160
    s_nop 0
    s_cmp_eq_u32 s61, 0
    s_nop 1
    s_cbranch_scc1 QN_46
    s_mov_b32 s62, 2
    s_branch QS_41
QN_46:
    s_waitcnt vmcnt(3)
    global_load_dwordx4 v[92:95], v11, s[8:9] nt
    v_add_u32 v11, s63, v11
    s_cmp_lg_u32 s62, 0
    s_cbranch_scc1 QN_47
    ds_read_b32 v160, v164 offset:16160
    ds_read_b128 v[152:155], v166
    ds_read_b128 v[156:159], v165
    s_waitcnt lgkmcnt(2)
    v_readfirstlane_b32 s61, v160
    s_nop 0
    s_cmp_eq_u32 s61, 0
    s_nop 1
    s_cbranch_scc1 QN_47
    s_mov_b32 s62, 3
    s_branch QS_41
QN_47:
    s_waitcnt vmcnt(3)
    global_load_dwordx4 v[96:99], v11, s[8:9] nt
    v_add_u32 v11, s63, v11
    s_cmp_lg_u32 s62, 0
    s_cbranch_scc1 QN_48
    ds_read_b32 v160, v164 offset:16160
    ds_read_b128 v[152:155], v166
    ds_read_b128 v[156:159], v165
    s_waitcnt lgkmcnt(2)
    v_readfirstlane_b32 s61, v160
    s_nop 0
    s_cmp_eq_u32 s61, 0
    s_nop 1
    s_cbranch_scc1 QN_48
    s_mov_b32 s62, 4
    s_branch QS_41
QN_48:
    s_waitcnt vmcnt(3)
    global_load_dwordx4 v[100:103], v11, s[8:9] nt
    s_cmp_lg_u32 s62, 0
    s_cbranch_scc1 PV_42
    s_mov_b32 s58, 0
QSPIN_43:
    ds_read_b32 v160, v164 offset:16160
    ds_read_b128 v[152:155], v166
    ds_read_b128 v[156:159], v165
    s_add_u32 s58, s58, 1
    s_waitcnt lgkmcnt(2)
    v_readfirstlane_b32 s61, v160
    s_cmp_ge_u32 s58, 480000
    s_nop 2
    s_cbranch_scc1 QS_41
    s_cmp_eq_u32 s61, 0
    s_cbranch_scc1 QSPIN_43
QS_41:
    s_waitcnt lgkmcnt(1)
    v_mfma_f32_16x16x32_bf16 v[12:15], v[40:43], v[152:155], 0
    v_mfma_f32_16x16x32_bf16 v[16:19], v[48:51], v[152:155], 0
    v_mfma_f32_16x16x32_bf16 v[20:23], v[56:59], v[152:155], 0
    v_mfma_f32_16x16x32_bf16 v[24:27], v[64:67], v[152:155], 0
    s_waitcnt lgkmcnt(0)
    v_mfma_f32_16x16x32_bf16 v[12:15], v[44:47], v[156:159], v[12:15]
    v_mfma_f32_16x16x32_bf16 v[16:19], v[52:55], v[156:159], v[16:19]
    v_mfma_f32_16x16x32_bf16 v[20:23], v[60:63], v[156:159], v[20:23]
    v_mfma_f32_16x16x32_bf16 v[24:27], v[68:71], v[156:159], v[24:27]
    s_nop 4
    v_add_f32_dpp v29, v13, v12 row_ror:12 row_mask:0xf bank_mask:0xf
    v_add_f32_dpp v30, v18, v17 row_ror:12 row_mask:0xf bank_mask:0xf
    v_add_f32_dpp v31, v23, v22 row_ror:12 row_mask:0xf bank_mask:0xf
    v_add_f32_dpp v32, v24, v27 row_ror:12 row_mask:0xf bank_mask:0xf
    v_add_f32_dpp v29, v14, v29 row_ror:8 row_mask:0xf bank_mask:0xf
    v_add_f32_dpp v30, v19, v30 row_ror:8 row_mask:0xf bank_mask:0xf
    v_add_f32_dpp v31, v20, v31 row_ror:8 row_mask:0xf bank_mask:0xf
    v_add_f32_dpp v32, v25, v32 row_ror:8 row_mask:0xf bank_mask:0xf
    v_add_f32_dpp v28, v15, v29 row_ror:4 row_mask:0xf bank_mask:0x1
    s_nop 1
    v_add_f32_dpp v28, v16, v30 row_ror:4 row_mask:0xf bank_mask:0x2
    s_nop 1
    v_add_f32_dpp v28, v21, v31 row_ror:4 row_mask:0xf bank_mask:0x4
    s_nop 1
    v_add_f32_dpp v28, v26, v32 row_ror:4 row_mask:0xf bank_mask:0x8
    v_cvt_pk_bf16_f32 v28, 0, v28
    v_mul_f32 v28, 0x3db504f3, v28
    v_cvt_pk_bf16_f32 v28, 0, v28
    s_nop 1
    v_max_f32_dpp v29, v28, v28 quad_perm:[2,3,0,1] row_mask:0xf bank_mask:0xf
    s_nop 1
    v_max_f32_dpp v29, v29, v29 row_ror:4 row_mask:0xf bank_mask:0xf
    s_nop 1
    v_max_f32_dpp v29, v29, v29 row_ror:8 row_mask:0xf bank_mask:0xf
    v_mov_b32 v30, v29
    s_nop 1
    v_permlane16_swap_b32 v29, v30
    v_max_f32 v29, v29, v30
    v_mov_b32 v30, v29
    s_nop 1
    v_permlane32_swap_b32 v29, v30
    v_max_f32 v29, v29, v30
    v_mul_f32 v29, s60, v29
    v_and_b32 v29, 0xffffff00, v29
    v_fma_f32 v28, v28, s60, -v29
    v_exp_f32 v28, v28
    s_nop 0
    v_cvt_pk_bf16_f32 v30, v28, v28
    v_add_f32_dpp v28, v28, v28 quad_perm:[2,3,0,1] row_mask:0xf bank_mask:0xf
    s_nop 0
    v_mov_b32_dpp v31, v30 row_ror:4 row_mask:0xf bank_mask:0xf
    v_add_f32_dpp v28, v28, v28 row_ror:4 row_mask:0xf bank_mask:0xf
    v_mov_b32_dpp v32, v30 row_ror:8 row_mask:0xf bank_mask:0xf
    s_nop 0
    v_add_f32_dpp v28, v28, v28 row_ror:8 row_mask:0xf bank_mask:0xf
    v_mov_b32_dpp v33, v30 row_ror:12 row_mask:0xf bank_mask:0xf
    s_mov_b32 exec_lo, 0x30003
    s_mov_b32 exec_hi, 0x30003
    ds_write_b32 v163, v29 offset:16176
    ds_add_f32 v163, v28 offset:16180
    ds_add_u32 v164, v9 offset:16156
    s_mov_b64 exec, -1
    v_and_b32_dpp v40, v30, v5 quad_perm:[0,1,0,1] row_mask:0xf bank_mask:0xf
    v_and_b32_dpp v41, v31, v6 quad_perm:[0,1,0,1] row_mask:0xf bank_mask:0xf
    v_and_b32_dpp v42, v32, v7 quad_perm:[0,1,0,1] row_mask:0xf bank_mask:0xf
    v_and_b32_dpp v43, v33, v8 quad_perm:[0,1,0,1] row_mask:0xf bank_mask:0xf
    v_and_b32_dpp v44, v30, v5 quad_perm:[2,3,2,3] row_mask:0xf bank_mask:0xf
    v_and_b32_dpp v45, v31, v6 quad_perm:[2,3,2,3] row_mask:0xf bank_mask:0xf
    v_and_b32_dpp v46, v32, v7 quad_perm:[2,3,2,3] row_mask:0xf bank_mask:0xf
    v_and_b32_dpp v47, v33, v8 quad_perm:[2,3,2,3] row_mask:0xf bank_mask:0xf
    v_and_b32_dpp v48, v33, v5 quad_perm:[0,1,0,1] row_mask:0xf bank_mask:0xf
    v_and_b32_dpp v49, v30, v6 quad_perm:[0,1,0,1] row_mask:0xf bank_mask:0xf
    v_and_b32_dpp v50, v31, v7 quad_perm:[0,1,0,1] row_mask:0xf bank_mask:0xf
    v_and_b32_dpp v51, v32, v8 quad_perm:[0,1,0,1] row_mask:0xf bank_mask:0xf
    v_and_b32_dpp v52, v33, v5 quad_perm:[2,3,2,3] row_mask:0xf bank_mask:0xf
    v_and_b32_dpp v53, v30, v6 quad_perm:[2,3,2,3] row_mask:0xf bank_mask:0xf
    v_and_b32_dpp v54, v31, v7 quad_perm:[2,3,2,3] row_mask:0xf bank_mask:0xf
    v_and_b32_dpp v55, v32, v8 quad_perm:[2,3,2,3] row_mask:0xf bank_mask:0xf
    v_and_b32_dpp v56, v32, v5 quad_perm:[0,1,0,1] row_mask:0xf bank_mask:0xf
    v_and_b32_dpp v57, v33, v6 quad_perm:[0,1,0,1] row_mask:0xf bank_mask:0xf
    v_and_b32_dpp v58, v30, v7 quad_perm:[0,1,0,1] row_mask:0xf bank_mask:0xf
    v_and_b32_dpp v59, v31, v8 quad_perm:[0,1,0,1] row_mask:0xf bank_mask:0xf
    v_and_b32_dpp v60, v32, v5 quad_perm:[2,3,2,3] row_mask:0xf bank_mask:0xf
    v_and_b32_dpp v61, v33, v6 quad_perm:[2,3,2,3] row_mask:0xf bank_mask:0xf
    v_and_b32_dpp v62, v30, v7 quad_perm:[2,3,2,3] row_mask:0xf bank_mask:0xf
    v_and_b32_dpp v63, v31, v8 quad_perm:[2,3,2,3] row_mask:0xf bank_mask:0xf
    v_and_b32_dpp v64, v31, v5 quad_perm:[0,1,0,1] row_mask:0xf bank_mask:0xf
    v_and_b32_dpp v65, v32, v6 quad_perm:[0,1,0,1] row_mask:0xf bank_mask:0xf
    v_and_b32_dpp v66, v33, v7 quad_perm:[0,1,0,1] row_mask:0xf bank_mask:0xf
    v_and_b32_dpp v67, v30, v8 quad_perm:[0,1,0,1] row_mask:0xf bank_mask:0xf
    v_and_b32_dpp v68, v31, v5 quad_perm:[2,3,2,3] row_mask:0xf bank_mask:0xf
    v_and_b32_dpp v69, v32, v6 quad_perm:[2,3,2,3] row_mask:0xf bank_mask:0xf
    v_and_b32_dpp v70, v33, v7 quad_perm:[2,3,2,3] row_mask:0xf bank_mask:0xf
    v_and_b32_dpp v71, v30, v8 quad_perm:[2,3,2,3] row_mask:0xf bank_mask:0xf
    v_lshlrev_b32 v16, 4, v0
    s_lshl_b32 s43, s35, 10
    v_add_u32 v16, s43, v16
    s_cmp_eq_u32 s62, 1
    s_cbranch_scc1 QN_45
    s_cmp_eq_u32 s62, 2
    s_cbranch_scc1 QN_46
    s_cmp_eq_u32 s62, 3
    s_cbranch_scc1 QN_47
    s_cmp_eq_u32 s62, 4
    s_cbranch_scc1 QN_48
PV_42:
    s_waitcnt vmcnt(7)
    v_mfma_f32_16x16x32_bf16 v[12:15], v[40:43], v[72:75], 0
    global_load_ushort v38, v38, s[4:5]
    s_waitcnt vmcnt(7)
    v_mfma_f32_16x16x32_bf16 v[12:15], v[44:47], v[76:79], v[12:15]
    global_load_ushort v39, v39, s[18:19]
    s_waitcnt vmcnt(7)
    v_mfma_f32_16x16x32_bf16 v[12:15], v[48:51], v[80:83], v[12:15]
    s_waitcnt vmcnt(6)
    v_mfma_f32_16x16x32_bf16 v[12:15], v[52:55], v[84:87], v[12:15]
    s_waitcnt vmcnt(5)
    v_mfma_f32_16x16x32_bf16 v[12:15], v[56:59], v[88:91], v[12:15]
    s_waitcnt vmcnt(4)
    v_mfma_f32_16x16x32_bf16 v[12:15], v[60:63], v[92:95], v[12:15]
    s_waitcnt vmcnt(3)
    v_mfma_f32_16x16x32_bf16 v[12:15], v[64:67], v[96:99], v[12:15]
    global_load_dwordx4 v[104:107], v34, s[16:17] nt
    v_add_u32 v34, 36864, v34
    s_waitcnt vmcnt(3)
    v_mfma_f32_16x16x32_bf16 v[12:15], v[68:71], v[100:103], v[12:15]
    global_load_dwordx4 v[108:111], v34, s[16:17] nt
    v_add_u32 v34, 36864, v34
    s_nop 5
    ds_write_b128 v16, v[12:15] offset:6400
    s_waitcnt lgkmcnt(0)
    s_barrier
    s_barrier
    global_load_dwordx4 v[112:115], v34, s[16:17] nt
    v_add_u32 v34, 36864, v34
    global_load_dwordx4 v[116:119], v34, s[16:17] nt
    global_load_dwordx4 v[120:123], v35, s[20:21] offset:0 nt
    global_load_dwordx4 v[124:127], v35, s[20:21] offset:1152 nt
    global_load_dwordx4 v[128:131], v35, s[20:21] offset:2304 nt
    global_load_dwordx4 v[132:135], v35, s[20:21] offset:3456 nt
    s_branch JOIN_40
IDLE_39:
    s_mov_b64 exec, 0xff
    ds_add_u32 v164, v9 offset:16156
    s_mov_b64 exec, -1
    global_load_ushort v38, v38, s[4:5]
    global_load_ushort v39, v39, s[18:19]
    global_load_dwordx4 v[104:107], v34, s[16:17] nt
    v_add_u32 v34, 36864, v34
    global_load_dwordx4 v[108:111], v34, s[16:17] nt
    v_add_u32 v34, 36864, v34
    s_waitcnt vmcnt(3)
    global_load_dwordx4 v[112:115], v34, s[16:17] nt
    v_add_u32 v34, 36864, v34
    s_waitcnt vmcnt(3)
    global_load_dwordx4 v[116:119], v34, s[16:17] nt
    s_waitcnt vmcnt(3)
    global_load_dwordx4 v[120:123], v35, s[20:21] offset:0 nt
    s_waitcnt vmcnt(3)
    global_load_dwordx4 v[124:127], v35, s[20:21] offset:1152 nt
    s_waitcnt vmcnt(3)
    global_load_dwordx4 v[128:131], v35, s[20:21] offset:2304 nt
    s_waitcnt vmcnt(3)
    global_load_dwordx4 v[132:135], v35, s[20:21] offset:3456 nt
    s_barrier
    s_barrier
JOIN_40:
    v_or_b32 v40, v1, v3
    v_or_b32 v41, v2, v4
    v_and_b32 v42, s59, v40
    v_and_b32 v43, s59, v41
    v_mov_b32 v47, 0
    v_and_b32 v32, 3, v0
    v_lshlrev_b32 v44, 3, v32
    v_lshrrev_b32 v33, 5, v0
    v_lshl_add_u32 v44, v33, 2, v44
    v_bfe_u32 v33, v0, 3, 1
    v_lshl_add_u32 v44, v33, 1, v44
    v_bfe_u32 v33, v0, 4, 1
    v_add_u32 v44, v44, v33
    v_lshlrev_b32 v96, 3, v0
    v_mul_u32_u24 v44, 48, v44
    s_lshl_b32 s43, s35, 2
    v_add_u32 v44, s43, v44
    v_mul_u32_u24 v46, 18432, v33
    s_mul_i32 s43, s35, 36864
    s_lshl_b32 s44, s50, 7
    s_add_u32 s43, s43, s44
    s_add_u32 s43, s43, 786432
    v_and_b32 v33, 7, v0
    v_lshl_add_u32 v46, v33, 4, v46
    v_add_u32 v46, s43, v46
    v_sub_u32 v33, 35, v32
    v_and_b32 v45, 4, v0
    v_cmp_eq_u32 vcc, 0, v45
    s_nop 1
    v_cndmask_b32 v32, v33, v32, vcc
    v_lshrrev_b32 v45, 3, v0
    v_lshl_add_u32 v45, v45, 2, v32
    v_mul_u32_u24 v45, 48, v45
    s_mov_b32 s60, 0xff00ff00
    s_mov_b32 s61, 0xff00ff00
    s_mov_b32 s62, 0xf0f0f0f0
    s_mov_b32 s63, 0xf0f0f0f0
    v_mov_b32 v32, 0xc0135761
    s_mov_b64 s[52:53], -1
    s_mov_b64 s[54:55], -1
    s_mov_b32 s58, 0
    s_barrier
    global_load_dwordx4 v[136:139], v37, s[28:29] sc1
    global_load_dwordx4 v[140:143], v37, s[28:29] offset:1024 sc1
    s_waitcnt vmcnt(6)
    v_mfma_f32_16x16x16_bf16 v[56:59], v[42:43], v[104:105], 0
    v_mfma_f32_16x16x16_bf16 v[60:63], v[42:43], v[106:107], 0
    v_mfma_f32_16x16x16_bf16 v[56:59], v[42:43], v[108:109], v[56:59]
    v_mfma_f32_16x16x16_bf16 v[60:63], v[42:43], v[110:111], v[60:63]
    v_mfma_f32_16x16x16_bf16 v[56:59], v[42:43], v[112:113], v[56:59]
    v_mfma_f32_16x16x16_bf16 v[60:63], v[42:43], v[114:115], v[60:63]
    v_mfma_f32_16x16x16_bf16 v[56:59], v[42:43], v[116:117], v[56:59]
    v_mfma_f32_16x16x16_bf16 v[60:63], v[42:43], v[118:119], v[60:63]
    v_lshlrev_b32 v38, 16, v38
    v_lshlrev_b32 v39, 16, v39
    s_nop 5
    v_permlane32_swap_b32 v56, v60
    v_permlane32_swap_b32 v57, v61
    v_permlane32_swap_b32 v58, v62
    v_permlane32_swap_b32 v59, v63
    v_cndmask_b32 v56, v56, v60, s[60:61]
    v_cndmask_b32 v57, v57, v61, s[60:61]
    v_cndmask_b32 v58, v58, v62, s[60:61]
    v_cndmask_b32 v59, v59, v63, s[60:61]
    v_permlane16_swap_b32 v56, v57
    s_nop 0
    v_permlane16_swap_b32 v58, v59
    v_cndmask_b32 v56, v56, v57, s[62:63]
    v_cndmask_b32 v58, v58, v59, s[62:63]
    s_nop 0
    v_add_f32_dpp v60, v56, v56 row_ror:8 row_mask:0xf bank_mask:0x3
    s_nop 1
    v_add_f32_dpp v60, v58, v58 row_ror:8 row_mask:0xf bank_mask:0xc
    s_nop 1
    v_add_f32_dpp v60, v60, v60 row_ror:4 row_mask:0xf bank_mask:0xf
    s_mov_b32 exec_lo, 0xf0f0f0f0
    s_mov_b32 exec_hi, 0xf0f0f0f0
    ds_write_b32 v44, v60 offset:18480
    s_mov_b64 exec, -1
    s_branch DCHK_51
DPOLL_49:
    s_mov_b64 exec, s[52:53]
    global_load_dwordx4 v[136:139], v37, s[28:29] sc1
    s_mov_b64 exec, s[54:55]
    global_load_dwordx4 v[140:143], v37, s[28:29] offset:1024 sc1
DCHK_51:
    s_mov_b64 exec, s[52:53]
    s_cbranch_execz DSKIP_52
    s_waitcnt vmcnt(1)
    v_xor_b32 v136, s31, v136
    v_xor_b32 v137, s32, v137
    v_xor_b32 v138, s33, v138
    v_xor_b32 v139, s34, v139
    v_or3_b32 v12, v136, v137, v138
    v_or_b32 v12, v139, v12
    v_cmp_ne_u32_sdwa s[52:53], v12, 0 src0_sel:BYTE_0 src1_sel:DWORD
DSKIP_52:
    s_mov_b64 exec, s[54:55]
    s_nop 2
    s_cbranch_execz DSKIP_53
    s_waitcnt vmcnt(0)
    v_xor_b32 v140, s31, v140
    v_xor_b32 v141, s32, v141
    v_xor_b32 v142, s33, v142
    v_xor_b32 v143, s34, v143
    v_or3_b32 v12, v140, v141, v142
    v_or_b32 v12, v143, v12
    v_cmp_ne_u32_sdwa s[54:55], v12, 0 src0_sel:BYTE_0 src1_sel:DWORD
DSKIP_53:
    s_add_u32 s58, s58, 1
    s_cmp_ge_u32 s58, 60000
    s_nop 1
    s_cbranch_scc1 DDONE_50
    s_or_b64 vcc, s[52:53], s[54:55]
    s_cbranch_scc1 DPOLL_49
DDONE_50:
    s_mov_b64 exec, -1
    s_waitcnt vmcnt(0)
    v_pk_add_f32 v[136:137], v[136:137], v[140:141]
    v_pk_add_f32 v[138:139], v[138:139], v[142:143]
    s_nop 1
    v_permlane32_swap_b32 v136, v138
    v_permlane32_swap_b32 v137, v139
    v_add_f32 v136, v136, v138
    v_add_f32 v137, v137, v139
    s_nop 1
    v_permlane16_swap_b32 v136, v137
    v_add_f32 v12, v136, v137
    v_cvt_pk_bf16_f32 v12, 0, v12
    v_add_f32 v12, v12, v38
    v_cvt_pk_bf16_f32 v13, v12, v12
    v_cvt_pk_bf16_f32 v14, 0, v12
    v_mul_f32 v15, v14, v14
    v_and_b32_dpp v64, v13, v40 quad_perm:[0,0,0,0] row_mask:0xf bank_mask:0xf
    v_and_b32_dpp v65, v13, v41 quad_perm:[0,0,0,0] row_mask:0xf bank_mask:0xf
    v_and_b32_dpp v66, v13, v40 quad_perm:[1,1,1,1] row_mask:0xf bank_mask:0xf
    v_and_b32_dpp v67, v13, v41 quad_perm:[1,1,1,1] row_mask:0xf bank_mask:0xf
    v_mfma_f32_16x16x16_bf16 v[48:51], v[64:65], v[104:105], 0
    v_mfma_f32_16x16x16_bf16 v[52:55], v[64:65], v[106:107], 0
    v_add_f32_dpp v14, v14, v14 quad_perm:[1,0,3,2] row_mask:0xf bank_mask:0xf
    v_add_f32_dpp v15, v15, v15 quad_perm:[1,0,3,2] row_mask:0xf bank_mask:0xf
    v_and_b32_dpp v68, v13, v40 quad_perm:[2,2,2,2] row_mask:0xf bank_mask:0xf
    v_and_b32_dpp v69, v13, v41 quad_perm:[2,2,2,2] row_mask:0xf bank_mask:0xf
    v_mfma_f32_16x16x16_bf16 v[48:51], v[66:67], v[108:109], v[48:51]
    v_mfma_f32_16x16x16_bf16 v[52:55], v[66:67], v[110:111], v[52:55]
    v_add_f32_dpp v14, v14, v14 quad_perm:[2,3,0,1] row_mask:0xf bank_mask:0xf
    v_add_f32_dpp v15, v15, v15 quad_perm:[2,3,0,1] row_mask:0xf bank_mask:0xf
    v_and_b32_dpp v70, v13, v40 quad_perm:[3,3,3,3] row_mask:0xf bank_mask:0xf
    v_and_b32_dpp v71, v13, v41 quad_perm:[3,3,3,3] row_mask:0xf bank_mask:0xf
    v_mfma_f32_16x16x16_bf16 v[48:51], v[68:69], v[112:113], v[48:51]
    v_mfma_f32_16x16x16_bf16 v[52:55], v[68:69], v[114:115], v[52:55]
    v_add_f32_dpp v14, v14, v14 row_half_mirror row_mask:0xf bank_mask:0xf
    v_add_f32_dpp v15, v15, v15 row_half_mirror row_mask:0xf bank_mask:0xf
    v_mfma_f32_16x16x16_bf16 v[48:51], v[70:71], v[116:117], v[48:51]
    v_mfma_f32_16x16x16_bf16 v[52:55], v[70:71], v[118:119], v[52:55]
    v_add_f32_dpp v14, v14, v14 row_mirror row_mask:0xf bank_mask:0xf
    v_add_f32_dpp v15, v15, v15 row_mirror row_mask:0xf bank_mask:0xf
    s_mov_b32 exec_lo, 0x10001
    s_mov_b32 exec_hi, 0x10001
    ds_add_f32 v47, v14 offset:16144
    ds_add_f32 v47, v15 offset:16148
    s_mov_b64 exec, -1
    s_nop 0
    v_permlane32_swap_b32 v48, v52
    v_permlane32_swap_b32 v49, v53
    v_permlane32_swap_b32 v50, v54
    v_permlane32_swap_b32 v51, v55
    v_cndmask_b32 v48, v48, v52, s[60:61]
    v_cndmask_b32 v49, v49, v53, s[60:61]
    v_cndmask_b32 v50, v50, v54, s[60:61]
    v_cndmask_b32 v51, v51, v55, s[60:61]
    v_permlane16_swap_b32 v48, v49
    s_nop 0
    v_permlane16_swap_b32 v50, v51
    v_cndmask_b32 v48, v48, v49, s[62:63]
    v_cndmask_b32 v50, v50, v51, s[62:63]
    s_nop 0
    v_add_f32_dpp v52, v48, v48 row_ror:8 row_mask:0xf bank_mask:0x3
    s_nop 1
    v_add_f32_dpp v52, v50, v50 row_ror:8 row_mask:0xf bank_mask:0xc
    s_nop 1
    v_add_f32_dpp v52, v52, v52 row_ror:4 row_mask:0xf bank_mask:0xf
    s_mov_b32 exec_lo, 0xf0f0f0f0
    s_mov_b32 exec_hi, 0xf0f0f0f0
    ds_write_b32 v44, v52 offset:16944
    s_mov_b64 exec, -1
    s_waitcnt lgkmcnt(0)
    s_cmp_lt_u32 s35, 1
    s_barrier
    s_cbranch_scc1 L_GP
    s_barrier
    ds_read_b64 v[16:17], v96 offset:0
    s_waitcnt lgkmcnt(0)
    s_branch L_GJ
L_GP:
    ds_read_b64 v[12:13], v47 offset:16144
    ds_read_b128 v[16:19], v45 offset:16944
    ds_read_b128 v[20:23], v45 offset:16960
    ds_read_b32 v24, v45 offset:16976
    s_waitcnt lgkmcnt(3)
    v_mul_f32 v12, 0xbae38e39, v12
    v_mul_f32 v13, 0x3ae38e39, v13
    v_fma_f32 v13, -v12, v12, v13
    v_cvt_pk_bf16_f32 v14, 0, v12
    v_max_f32 v13, 0, v13
    v_cvt_pk_bf16_f32 v15, 0, v13
    v_sub_f32 v26, v14, v12
    v_add_f32 v15, 0x3727c5ac, v15
    v_cvt_pk_bf16_f32 v15, 0, v15
    v_sqrt_f32 v15, v15
    s_waitcnt lgkmcnt(1)
    v_pk_add_f32 v[16:17], v[16:17], v[20:21]
    v_cvt_pk_bf16_f32 v15, 0, v15
    v_rcp_f32 v15, v15
    v_pk_add_f32 v[18:19], v[18:19], v[22:23]
    v_mul_f32 v27, v13, v15
    v_mul_f32 v26, v26, v15
    v_mul_f32 v27, v27, v15
    v_cvt_pk_bf16_f32 v26, 0, v26
    v_cvt_pk_bf16_f32 v27, 0, v27
    v_pk_add_f32 v[16:17], v[16:17], v[18:19]
    v_add_f32 v27, 0x3727c5ac, v27
    v_fma_f32 v26, v14, v15, -v26
    v_cvt_pk_bf16_f32 v27, 0, v27
    v_add_f32 v16, v16, v17
    v_sqrt_f32 v27, v27
    s_waitcnt lgkmcnt(0)
    v_add_f32 v16, v16, v24
    v_cvt_pk_bf16_f32 v27, 0, v27
    v_mul_f32 v28, v16, v15
    v_rcp_f32 v27, v27
    s_nop 0
    v_fmac_f32_dpp v28, v16, v26 row_half_mirror row_mask:0xf bank_mask:0xf
    v_mul_f32 v16, v28, v27
    v_cvt_pk_bf16_f32 v16, 0, v16
    v_add_f32 v16, v16, v39
    v_cvt_pk_bf16_f32 v16, 0, v16
    v_mul_f32 v17, v16, v16
    v_fmac_f32 v32, 0xbdd2d3e8, v17
    v_mul_f32 v17, v16, v32
    v_exp_f32 v17, v17
    s_nop 0
    v_add_f32 v17, 1.0, v17
    v_rcp_f32 v17, v17
    s_nop 0
    v_mul_f32 v16, v16, v17
    v_cvt_pk_bf16_f32 v16, v16, v16
    s_nop 1
    v_mov_b32_dpp v17, v16 row_half_mirror row_mask:0xf bank_mask:0xf
    ds_write_b64 v96, v[16:17] offset:0
    s_waitcnt lgkmcnt(0)
    s_barrier
L_GJ:
    v_and_b32_dpp v72, v16, v1 quad_perm:[0,0,0,0] row_mask:0xf bank_mask:0xf
    v_and_b32_dpp v73, v16, v2 quad_perm:[0,0,0,0] row_mask:0xf bank_mask:0xf
    v_and_b32_dpp v74, v17, v3 quad_perm:[3,3,3,3] row_mask:0xf bank_mask:0xf
    v_and_b32_dpp v75, v17, v4 quad_perm:[3,3,3,3] row_mask:0xf bank_mask:0xf
    v_and_b32_dpp v76, v16, v1 quad_perm:[1,1,1,1] row_mask:0xf bank_mask:0xf
    v_and_b32_dpp v77, v16, v2 quad_perm:[1,1,1,1] row_mask:0xf bank_mask:0xf
    v_and_b32_dpp v78, v17, v3 quad_perm:[2,2,2,2] row_mask:0xf bank_mask:0xf
    v_and_b32_dpp v79, v17, v4 quad_perm:[2,2,2,2] row_mask:0xf bank_mask:0xf
    v_mfma_f32_16x16x32_bf16 v[88:91], v[72:75], v[120:123], 0
    v_and_b32_dpp v80, v16, v1 quad_perm:[2,2,2,2] row_mask:0xf bank_mask:0xf
    v_and_b32_dpp v81, v16, v2 quad_perm:[2,2,2,2] row_mask:0xf bank_mask:0xf
    v_and_b32_dpp v82, v17, v3 quad_perm:[1,1,1,1] row_mask:0xf bank_mask:0xf
    v_and_b32_dpp v83, v17, v4 quad_perm:[1,1,1,1] row_mask:0xf bank_mask:0xf
    v_mfma_f32_16x16x32_bf16 v[88:91], v[76:79], v[124:127], v[88:91]
    v_and_b32_dpp v84, v16, v1 quad_perm:[3,3,3,3] row_mask:0xf bank_mask:0xf
    v_and_b32_dpp v85, v16, v2 quad_perm:[3,3,3,3] row_mask:0xf bank_mask:0xf
    v_and_b32_dpp v86, v17, v3 quad_perm:[0,0,0,0] row_mask:0xf bank_mask:0xf
    v_and_b32_dpp v87, v17, v4 quad_perm:[0,0,0,0] row_mask:0xf bank_mask:0xf
    v_mfma_f32_16x16x32_bf16 v[88:91], v[80:83], v[128:131], v[88:91]
    s_nop 0
    v_mfma_f32_16x16x32_bf16 v[88:91], v[84:87], v[132:135], v[88:91]
    s_nop 7
    v_permlane32_swap_b32 v88, v92
    v_permlane32_swap_b32 v89, v93
    v_permlane32_swap_b32 v90, v94
    v_permlane32_swap_b32 v91, v95
    v_add_f32_dpp v88, v92, v88 row_ror:8 row_mask:0xf bank_mask:0xf
    v_add_f32_dpp v89, v93, v89 row_ror:8 row_mask:0xf bank_mask:0xf
    v_add_f32_dpp v90, v94, v90 row_ror:8 row_mask:0xf bank_mask:0xf
    v_add_f32_dpp v91, v95, v91 row_ror:8 row_mask:0xf bank_mask:0xf
    v_bfi_b32 v88, v9, s31, v88
    v_bfi_b32 v89, v9, s32, v89
    v_bfi_b32 v90, v9, s33, v90
    v_bfi_b32 v91, v9, s34, v91
    s_mov_b32 exec_lo, 0xff00ff
    s_mov_b32 exec_hi, 0x0
    global_store_dwordx4 v46, v[88:91], s[28:29] sc1
    s_endpgm
L_C:
    s_getpc_b64 s[44:45]
L_PC0:
    s_sub_u32 s44, s44, L_PC0-sequential_preLN__sliding_block_cached__mixer_channel_mlp__decode_kernel
    s_subb_u32 s45, s45, 0
    s_bfe_u32 s43, s2, 0x30003
    v_lshlrev_b32 v2, 10, v0
    s_lshl_b32 s43, s43, 7
    v_add_u32 v2, s43, v2
    v_min_u32 v2, L_CODE_END-sequential_preLN__sliding_block_cached__mixer_channel_mlp__decode_kernel-128, v2
    s_mov_b64 exec, 0xffffff
    global_load_dword v136, v2, s[44:45]
    s_mov_b64 exec, -1
    v_lshlrev_b32 v107, 4, v0
    v_mov_b32 v40, 0
    v_mov_b32 v41, 0
    v_mov_b32 v42, 0
    v_mov_b32 v43, 0
    v_lshlrev_b32 v109, 3, v0
    ds_write_b64 v109, v[40:41] offset:16128
    v_mov_b32 v44, 0xff800000
    v_mov_b32 v45, 0
    ds_write_b64 v109, v[44:45] offset:16176
    ds_write_b64 v109, v[40:41] offset:5760
    ds_write_b64 v109, v[40:41] offset:5888
    s_waitcnt lgkmcnt(0)
    s_load_dword s30, s[28:29], 0
    s_barrier
    s_setprio 3
    ds_write_b128 v107, v[40:43] offset:13568
    ds_write_b128 v107, v[40:43] offset:14592
    v_mov_b32 v9, 0xff
    v_bfe_u32 v104, v0, 2, 2
    v_lshrrev_b32 v105, 4, v0
    v_and_b32 v106, 3, v0
    v_lshl_add_u32 v105, v105, 2, v106
    v_mul_u32_u24 v104, 320, v104
    v_lshl_add_u32 v104, v105, 4, v104
    v_lshlrev_b32 v106, 4, v105
    s_lshl_b32 s43, s38, 12
    s_add_u32 s43, s43, 65536
    s_lshl2_add_u32 s44, s41, s40
    s_lshl_b32 s44, s44, 8
    s_add_u32 s44, s44, s43
    v_add_u32 v105, s44, v106
    v_add_u32 v108, s43, v107
    s_lshl_b32 s43, s38, 4
    s_add_u32 s43, s43, s39
    s_lshl_b32 s44, s43, 10
    s_add_u32 s44, s44, 262144
    v_add_u32 v110, s44, v107
    s_lshl_b32 s44, s43, 4
    s_add_u32 s44, s44, 131072
    v_mov_b32 v111, s44
    v_and_b32 v113, 15, v0
    v_bfe_u32 v112, v0, 4, 1
    v_lshlrev_b32 v113, 4, v113
    v_lshl_add_u32 v113, v112, 3, v113
    s_waitcnt lgkmcnt(0)
    s_mul_i32 s31, s30, 0x9e3779b1
    s_lshr_b32 s32, s30, 13
    s_xor_b32 s31, s31, s32
    s_and_b32 s31, s31, 0x7e7e7e7e
    s_or_b32 s31, s31, 0x01010101
    s_add_u32 s30, s31, s30
    s_and_b32 s31, s30, 0xff
    s_bfe_u32 s32, s30, 0x80008
    s_bfe_u32 s33, s30, 0x80010
    s_lshr_b32 s34, s30, 24
    s_mov_b64 exec, 1
    s_mov_b32 s58, 0
L_CNTW:
    ds_read_b32 v40, v0 offset:16152
    s_add_u32 s58, s58, 1
    s_waitcnt lgkmcnt(0)
    v_readfirstlane_b32 s45, v40
    s_cmp_ge_u32 s58, 60000
    s_nop 2
    s_cbranch_scc1 L_CNTD
    s_cmp_lt_u32 s45, 2295
    s_cbranch_scc1 L_CNTW
L_CNTD:
    s_mov_b64 exec, -1
    ds_read_b128 v[40:43], v104 offset:0
    ds_read_b128 v[44:47], v104 offset:1280
    ds_read_b128 v[48:51], v104 offset:2560
    ds_read_b128 v[52:55], v104 offset:3840
    ds_read_b128 v[56:59], v104 offset:5120
    s_waitcnt lgkmcnt(3)
    v_pk_add_f32 v[40:41], v[40:41], v[44:45]
    v_pk_add_f32 v[42:43], v[42:43], v[46:47]
    s_waitcnt lgkmcnt(2)
    v_pk_add_f32 v[40:41], v[40:41], v[48:49]
    v_pk_add_f32 v[42:43], v[42:43], v[50:51]
    s_waitcnt lgkmcnt(1)
    v_pk_add_f32 v[40:41], v[40:41], v[52:53]
    v_pk_add_f32 v[42:43], v[42:43], v[54:55]
    s_waitcnt lgkmcnt(0)
    v_pk_add_f32 v[40:41], v[40:41], v[56:57]
    v_pk_add_f32 v[42:43], v[42:43], v[58:59]
    s_nop 0
    v_add_f32_dpp v40, v40, v40 row_ror:4 row_mask:0xf bank_mask:0xf
    v_add_f32_dpp v41, v41, v41 row_ror:4 row_mask:0xf bank_mask:0xf
    v_add_f32_dpp v42, v42, v42 row_ror:4 row_mask:0xf bank_mask:0xf
    v_add_f32_dpp v43, v43, v43 row_ror:4 row_mask:0xf bank_mask:0xf
    v_add_f32_dpp v40, v40, v40 row_ror:8 row_mask:0xf bank_mask:0xf
    v_add_f32_dpp v41, v41, v41 row_ror:8 row_mask:0xf bank_mask:0xf
    v_add_f32_dpp v42, v42, v42 row_ror:8 row_mask:0xf bank_mask:0xf
    v_add_f32_dpp v43, v43, v43 row_ror:8 row_mask:0xf bank_mask:0xf
    v_bfi_b32 v40, v9, s31, v40
    v_bfi_b32 v41, v9, s32, v41
    v_bfi_b32 v42, v9, s33, v42
    v_bfi_b32 v43, v9, s34, v43
    s_mov_b32 exec_lo, 0xf000f
    s_mov_b32 exec_hi, 0xf000f
    global_store_dwordx4 v105, v[40:43], s[28:29] sc1
    s_mov_b64 exec, -1
    s_mov_b64 s[50:51], -1
    s_mov_b64 s[52:53], -1
    s_mov_b64 s[54:55], -1
    s_mov_b64 s[56:57], -1
    s_mov_b32 s58, 0
DPOLL_54:
    s_mov_b64 exec, s[50:51]
    global_load_dwordx4 v[136:139], v108, s[28:29] offset:0 sc1
    s_mov_b64 exec, s[52:53]
    global_load_dwordx4 v[140:143], v108, s[28:29] offset:1024 sc1
    s_mov_b64 exec, s[54:55]
    global_load_dwordx4 v[144:147], v108, s[28:29] offset:2048 sc1
    s_mov_b64 exec, s[56:57]
    global_load_dwordx4 v[148:151], v108, s[28:29] offset:3072 sc1
    s_mov_b64 exec, s[50:51]
    s_cbranch_execz DSKIP_57
    s_waitcnt vmcnt(3)
    v_xor_b32 v136, s31, v136
    v_xor_b32 v137, s32, v137
    v_xor_b32 v138, s33, v138
    v_xor_b32 v139, s34, v139
    v_or3_b32 v40, v136, v137, v138
    v_or_b32 v40, v139, v40
    v_cmp_ne_u32_sdwa s[50:51], v40, 0 src0_sel:BYTE_0 src1_sel:DWORD
DSKIP_57:
    s_mov_b64 exec, s[52:53]
    s_nop 2
    s_cbranch_execz DSKIP_58
    s_waitcnt vmcnt(2)
    v_xor_b32 v140, s31, v140
    v_xor_b32 v141, s32, v141
    v_xor_b32 v142, s33, v142
    v_xor_b32 v143, s34, v143
    v_or3_b32 v40, v140, v141, v142
    v_or_b32 v40, v143, v40
    v_cmp_ne_u32_sdwa s[52:53], v40, 0 src0_sel:BYTE_0 src1_sel:DWORD
DSKIP_58:
    s_mov_b64 exec, s[54:55]
    s_nop 2
    s_cbranch_execz DSKIP_59
    s_waitcnt vmcnt(1)
    v_xor_b32 v144, s31, v144
    v_xor_b32 v145, s32, v145
    v_xor_b32 v146, s33, v146
    v_xor_b32 v147, s34, v147
    v_or3_b32 v40, v144, v145, v146
    v_or_b32 v40, v147, v40
    v_cmp_ne_u32_sdwa s[54:55], v40, 0 src0_sel:BYTE_0 src1_sel:DWORD
DSKIP_59:
    s_mov_b64 exec, s[56:57]
    s_nop 2
    s_cbranch_execz DSKIP_60
    s_waitcnt vmcnt(0)
    v_xor_b32 v148, s31, v148
    v_xor_b32 v149, s32, v149
    v_xor_b32 v150, s33, v150
    v_xor_b32 v151, s34, v151
    v_or3_b32 v40, v148, v149, v150
    v_or_b32 v40, v151, v40
    v_cmp_ne_u32_sdwa s[56:57], v40, 0 src0_sel:BYTE_0 src1_sel:DWORD
DSKIP_60:
    s_add_u32 s58, s58, 1
    s_cmp_ge_u32 s58, 60000
    s_nop 1
    s_cbranch_scc1 DDONE_55
    s_or_b64 vcc, s[50:51], s[52:53]
    s_or_b64 vcc, vcc, s[54:55]
    s_or_b64 vcc, vcc, s[56:57]
    s_cbranch_scc1 DPOLL_54
DDONE_55:
    s_mov_b64 exec, -1
    s_waitcnt vmcnt(0)
    v_pk_add_f32 v[136:137], v[136:137], v[140:141]
    v_pk_add_f32 v[138:139], v[138:139], v[142:143]
    v_pk_add_f32 v[136:137], v[136:137], v[144:145]
    v_pk_add_f32 v[138:139], v[138:139], v[146:147]
    v_pk_add_f32 v[136:137], v[136:137], v[148:149]
    v_pk_add_f32 v[138:139], v[138:139], v[150:151]
    v_cvt_pk_bf16_f32 v136, v136, v137
    v_cvt_pk_bf16_f32 v137, v138, v139
    ds_write_b64 v109, v[136:137] offset:15616
    s_mov_b64 exec, 1
    ds_write_b32 v0, v9 offset:16160
    s_mov_b32 s58, 0
L_CN2W:
    ds_read_b32 v40, v0 offset:16156
    s_add_u32 s58, s58, 1
    s_waitcnt lgkmcnt(0)
    v_readfirstlane_b32 s45, v40
    s_cmp_ge_u32 s58, 480000
    s_nop 2
    s_cbranch_scc1 L_CN2D
    s_cmp_lt_u32 s45, 18360
    s_cbranch_scc1 L_CN2W
L_CN2D:
    s_mov_b64 exec, -1
    ds_read_b64 v[40:41], v113 offset:16176
    s_waitcnt lgkmcnt(0)
    v_max_f32_dpp v42, v40, v40 quad_perm:[1,0,3,2] row_mask:0xf bank_mask:0xf
    s_nop 1
    v_max_f32_dpp v42, v42, v42 quad_perm:[2,3,0,1] row_mask:0xf bank_mask:0xf
    s_nop 1
    v_max_f32_dpp v42, v42, v42 row_half_mirror row_mask:0xf bank_mask:0xf
    s_nop 1
    v_max_f32_dpp v42, v42, v42 row_mirror row_mask:0xf bank_mask:0xf
    v_sub_f32 v40, v40, v42
    v_exp_f32 v40, v40
    v_readlane_b32 s47, v42, 16
    v_mul_f32 v43, v40, v41
    s_nop 1
    v_add_f32_dpp v43, v43, v43 quad_perm:[1,0,3,2] row_mask:0xf bank_mask:0xf
    s_nop 1
    v_add_f32_dpp v43, v43, v43 quad_perm:[2,3,0,1] row_mask:0xf bank_mask:0xf
    s_nop 1
    v_add_f32_dpp v43, v43, v43 row_half_mirror row_mask:0xf bank_mask:0xf
    s_nop 1
    v_add_f32_dpp v43, v43, v43 row_mirror row_mask:0xf bank_mask:0xf
    v_mov_b32 v44, s47
    v_readlane_b32 s49, v43, 16
    s_nop 1
    v_mov_b32 v45, s49
    v_bfi_b32 v42, v9, s31, v42
    v_bfi_b32 v43, v9, s32, v43
    v_bfi_b32 v44, v9, s33, v44
    v_bfi_b32 v45, v9, s34, v45
    s_mov_b64 exec, 1
    global_store_dwordx4 v111, v[42:45], s[28:29] sc1
    s_mov_b64 exec, -1
    v_readlane_b32 s4, v40, 0
    v_readlane_b32 s5, v40, 16
    v_readlane_b32 s6, v40, 1
    v_readlane_b32 s7, v40, 17
    v_readlane_b32 s8, v40, 2
    v_readlane_b32 s9, v40, 18
    v_readlane_b32 s10, v40, 3
    v_readlane_b32 s11, v40, 19
    v_readlane_b32 s12, v40, 4
    v_readlane_b32 s13, v40, 20
    v_readlane_b32 s14, v40, 5
    v_readlane_b32 s15, v40, 21
    v_readlane_b32 s16, v40, 6
    v_readlane_b32 s17, v40, 22
    v_readlane_b32 s18, v40, 7
    v_readlane_b32 s19, v40, 23
    v_readlane_b32 s20, v40, 8
    v_readlane_b32 s21, v40, 24
    s_cmp_lt_u32 s37, 18
    s_nop 2
    s_cbranch_scc1 L_CM
    s_cmp_lt_u32 s37, 27
    s_cbranch_scc1 L_CO
    s_sub_u32 s50, s37, 27
    s_lshl3_add_u32 s50, s50, s36
    v_and_b32 v12, 7, v0
    v_lshlrev_b32 v13, 2, v12
    v_bfe_u32 v14, v0, 4, 1
    v_lshl_add_u32 v13, v14, 1, v13
    v_lshrrev_b32 v14, 5, v0
    v_add_u32 v13, v13, v14
    v_mul_u32_u24 v13, 48, v13
    v_lshrrev_b32 v14, 3, v0
    s_lshr_b32 s43, s50, 1
    s_lshl_b32 s43, s43, 11
    s_and_b32 s44, s50, 1
    s_lshl_b32 s44, s44, 4
    s_add_u32 s43, s43, s44
    s_add_u32 s43, s43, 524288
    s_and_b32 s44, s2, 7
    s_mul_i32 s44, s44, 18432
    s_add_u32 s43, s43, s44
    v_lshlrev_b32 v18, 8, v14
    v_lshl_add_u32 v18, v12, 5, v18
    v_add_u32 v18, s43, v18
    s_barrier
    ds_read_b128 v[40:43], v107 offset:6400
    ds_read_b128 v[44:47], v107 offset:7424
    ds_read_b128 v[48:51], v107 offset:8448
    ds_read_b128 v[52:55], v107 offset:9472
    ds_read_b128 v[56:59], v107 offset:10496
    ds_read_b128 v[60:63], v107 offset:11520
    ds_read_b128 v[64:67], v107 offset:12544
    ds_read_b128 v[68:71], v107 offset:13568
    s_waitcnt lgkmcnt(7)
    v_pk_mul_f32 v[40:41], v[40:41], s[4:5]
    v_pk_mul_f32 v[42:43], v[42:43], s[4:5]
    s_waitcnt lgkmcnt(6)
    v_pk_fma_f32 v[40:41], v[44:45], s[6:7], v[40:41]
    v_pk_fma_f32 v[42:43], v[46:47], s[6:7], v[42:43]
    s_waitcnt lgkmcnt(5)
    v_pk_fma_f32 v[40:41], v[48:49], s[8:9], v[40:41]
    v_pk_fma_f32 v[42:43], v[50:51], s[8:9], v[42:43]
    s_waitcnt lgkmcnt(4)
    v_pk_fma_f32 v[40:41], v[52:53], s[10:11], v[40:41]
    v_pk_fma_f32 v[42:43], v[54:55], s[10:11], v[42:43]
    s_waitcnt lgkmcnt(3)
    v_pk_fma_f32 v[40:41], v[56:57], s[12:13], v[40:41]
    v_pk_fma_f32 v[42:43], v[58:59], s[12:13], v[42:43]
    s_waitcnt lgkmcnt(2)
    v_pk_fma_f32 v[40:41], v[60:61], s[14:15], v[40:41]
    v_pk_fma_f32 v[42:43], v[62:63], s[14:15], v[42:43]
    s_waitcnt lgkmcnt(1)
    v_pk_fma_f32 v[40:41], v[64:65], s[16:17], v[40:41]
    v_pk_fma_f32 v[42:43], v[66:67], s[16:17], v[42:43]
    s_waitcnt lgkmcnt(0)
    v_pk_fma_f32 v[40:41], v[68:69], s[18:19], v[40:41]
    v_pk_fma_f32 v[42:43], v[70:71], s[18:19], v[42:43]
    v_bfi_b32 v40, v9, s31, v40
    v_bfi_b32 v41, v9, s32, v41
    v_bfi_b32 v42, v9, s33, v42
    v_bfi_b32 v43, v9, s34, v43
    global_store_dwordx4 v110, v[40:43], s[28:29] sc1
    s_cmp_ge_u32 s50, 18
    s_cbranch_scc1 L_FIN
    s_mov_b64 s[52:53], -1
    s_mov_b32 s58, 0
DPOLL_61:
    s_mov_b64 exec, s[52:53]
    global_load_dwordx4 v[136:139], v18, s[28:29] sc1
    s_mov_b64 exec, s[52:53]
    s_cbranch_execz DSKIP_64
    s_waitcnt vmcnt(0)
    v_xor_b32 v136, s31, v136
    v_xor_b32 v137, s32, v137
    v_xor_b32 v138, s33, v138
    v_xor_b32 v139, s34, v139
    v_or3_b32 v19, v136, v137, v138
    v_or_b32 v19, v139, v19
    v_cmp_ne_u32_sdwa s[52:53], v19, 0 src0_sel:BYTE_0 src1_sel:DWORD
DSKIP_64:
    s_add_u32 s58, s58, 1
    s_cmp_ge_u32 s58, 60000
    s_nop 1
    s_cbranch_scc1 DDONE_62
    s_cmp_lg_u64 s[52:53], 0
    s_cbranch_scc1 DPOLL_61
DDONE_62:
    s_mov_b64 exec, -1
    s_waitcnt vmcnt(0)
    v_add_f32_dpp v136, v136, v136 row_ror:8 row_mask:0xf bank_mask:0xf
    v_add_f32_dpp v137, v137, v137 row_ror:8 row_mask:0xf bank_mask:0xf
    v_add_f32_dpp v138, v138, v138 row_ror:8 row_mask:0xf bank_mask:0xf
    v_add_f32_dpp v139, v139, v139 row_ror:8 row_mask:0xf bank_mask:0xf
    v_permlane32_swap_b32 v136, v137
    s_nop 0
    v_permlane32_swap_b32 v138, v139
    v_add_f32 v136, v136, v137
    v_add_f32 v138, v138, v139
    s_nop 1
    v_permlane16_swap_b32 v136, v138
    v_add_f32 v19, v136, v138
    ds_write_b32 v13, v19 offset:16980
    s_waitcnt lgkmcnt(0)
    s_barrier
    s_endpgm
L_CM:
    s_mul_i32 s50, s36, 18
    s_add_u32 s50, s50, s37
    s_and_b32 s51, s2, 7
    s_mul_i32 s51, s51, 18432
    s_add_u32 s43, s51, 524288
    v_and_b32 v13, 7, v0
    v_lshlrev_b32 v13, 8, v13
    v_bfe_u32 v14, v0, 3, 1
    v_lshl_add_u32 v13, v14, 13, v13
    v_add_u32 v13, s43, v13
    s_barrier
    ds_read_b128 v[40:43], v107 offset:6400
    ds_read_b128 v[44:47], v107 offset:7424
    ds_read_b128 v[48:51], v107 offset:8448
    ds_read_b128 v[52:55], v107 offset:9472
    ds_read_b128 v[56:59], v107 offset:10496
    ds_read_b128 v[60:63], v107 offset:11520
    ds_read_b128 v[64:67], v107 offset:12544
    ds_read_b128 v[68:71], v107 offset:13568
    s_waitcnt lgkmcnt(7)
    v_pk_mul_f32 v[40:41], v[40:41], s[4:5]
    v_pk_mul_f32 v[42:43], v[42:43], s[4:5]
    s_waitcnt lgkmcnt(6)
    v_pk_fma_f32 v[40:41], v[44:45], s[6:7], v[40:41]
    v_pk_fma_f32 v[42:43], v[46:47], s[6:7], v[42:43]
    s_waitcnt lgkmcnt(5)
    v_pk_fma_f32 v[40:41], v[48:49], s[8:9], v[40:41]
    v_pk_fma_f32 v[42:43], v[50:51], s[8:9], v[42:43]
    s_waitcnt lgkmcnt(4)
    v_pk_fma_f32 v[40:41], v[52:53], s[10:11], v[40:41]
    v_pk_fma_f32 v[42:43], v[54:55], s[10:11], v[42:43]
    s_waitcnt lgkmcnt(3)
    v_pk_fma_f32 v[40:41], v[56:57], s[12:13], v[40:41]
    v_pk_fma_f32 v[42:43], v[58:59], s[12:13], v[42:43]
    s_waitcnt lgkmcnt(2)
    v_pk_fma_f32 v[40:41], v[60:61], s[14:15], v[40:41]
    v_pk_fma_f32 v[42:43], v[62:63], s[14:15], v[42:43]
    s_waitcnt lgkmcnt(1)
    v_pk_fma_f32 v[40:41], v[64:65], s[16:17], v[40:41]
    v_pk_fma_f32 v[42:43], v[66:67], s[16:17], v[42:43]
    s_waitcnt lgkmcnt(0)
    v_pk_fma_f32 v[40:41], v[68:69], s[18:19], v[40:41]
    v_pk_fma_f32 v[42:43], v[70:71], s[18:19], v[42:43]
    v_bfi_b32 v40, v9, s31, v40
    v_bfi_b32 v41, v9, s32, v41
    v_bfi_b32 v42, v9, s33, v42
    v_bfi_b32 v43, v9, s34, v43
    global_store_dwordx4 v110, v[40:43], s[28:29] sc1
    s_barrier
    s_branch L_SEND
    s_mov_b64 exec, 0xffff
    s_mov_b32 s58, 0
L_SENT:
    global_load_dwordx4 v[136:139], v13, s[28:29] sc1
    s_add_u32 s58, s58, 1
    s_waitcnt vmcnt(0)
    v_xor_b32 v136, s31, v136
    v_xor_b32 v137, s32, v137
    v_xor_b32 v138, s33, v138
    v_xor_b32 v139, s34, v139
    v_or3_b32 v14, v136, v137, v138
    v_or_b32 v14, v139, v14
    v_cmp_ne_u32_sdwa vcc, v14, 0 src0_sel:BYTE_0 src1_sel:DWORD
    s_cmp_ge_u32 s58, 60000
    s_cbranch_scc1 L_SEND
    s_bcnt1_i32_b64 s43, vcc
    s_cmp_gt_u32 s43, 16
    s_cbranch_scc1 L_SENT
L_SEND:
    s_barrier
    s_endpgm
L_CO:
    s_lshl_b32 s43, s36, 9
    s_add_u32 s43, s43, 131072
    v_and_b32 v12, 31, v0
    v_lshlrev_b32 v13, 3, v12
    v_lshlrev_b32 v12, 4, v12
    v_add_u32 v12, s43, v12
    s_sub_u32 s43, s37, 18
    s_lshl_b32 s43, s43, 11
    s_lshl_b32 s44, s36, 8
    s_add_u32 s43, s43, s44
    s_add_u32 s43, s43, 524288
    v_add_u32 v105, s43, v106
    v_bfe_u32 v14, v0, 2, 2
    v_mul_u32_u24 v14, 18432, v14
    v_add_u32 v105, v105, v14
    s_add_u32 s44, s28, 73728
    s_addc_u32 s45, s29, 0
    s_barrier
    ds_read_b128 v[40:43], v107 offset:6400
    ds_read_b128 v[44:47], v107 offset:7424
    ds_read_b128 v[48:51], v107 offset:8448
    ds_read_b128 v[52:55], v107 offset:9472
    ds_read_b128 v[56:59], v107 offset:10496
    ds_read_b128 v[60:63], v107 offset:11520
    ds_read_b128 v[64:67], v107 offset:12544
    ds_read_b128 v[68:71], v107 offset:13568
    global_load_dwordx4 v[136:139], v12, s[28:29] sc1
    s_waitcnt lgkmcnt(7)
    v_pk_mul_f32 v[40:41], v[40:41], s[4:5]
    v_pk_mul_f32 v[42:43], v[42:43], s[4:5]
    s_waitcnt lgkmcnt(6)
    v_pk_fma_f32 v[40:41], v[44:45], s[6:7], v[40:41]
    v_pk_fma_f32 v[42:43], v[46:47], s[6:7], v[42:43]
    s_waitcnt lgkmcnt(5)
    v_pk_fma_f32 v[40:41], v[48:49], s[8:9], v[40:41]
    v_pk_fma_f32 v[42:43], v[50:51], s[8:9], v[42:43]
    s_waitcnt lgkmcnt(4)
    v_pk_fma_f32 v[40:41], v[52:53], s[10:11], v[40:41]
    v_pk_fma_f32 v[42:43], v[54:55], s[10:11], v[42:43]
    s_waitcnt lgkmcnt(3)
    v_pk_fma_f32 v[40:41], v[56:57], s[12:13], v[40:41]
    v_pk_fma_f32 v[42:43], v[58:59], s[12:13], v[42:43]
    s_waitcnt lgkmcnt(2)
    v_pk_fma_f32 v[40:41], v[60:61], s[14:15], v[40:41]
    v_pk_fma_f32 v[42:43], v[62:63], s[14:15], v[42:43]
    s_waitcnt lgkmcnt(1)
    v_pk_fma_f32 v[40:41], v[64:65], s[16:17], v[40:41]
    v_pk_fma_f32 v[42:43], v[66:67], s[16:17], v[42:43]
    s_waitcnt lgkmcnt(0)
    v_pk_fma_f32 v[40:41], v[68:69], s[18:19], v[40:41]
    v_pk_fma_f32 v[42:43], v[70:71], s[18:19], v[42:43]
    v_bfi_b32 v40, v9, s31, v40
    v_bfi_b32 v41, v9, s32, v41
    v_bfi_b32 v42, v9, s33, v42
    v_bfi_b32 v43, v9, s34, v43
    global_store_dwordx4 v110, v[40:43], s[28:29] sc1
    s_mov_b32 s58, 0
    s_branch PWAIT_67
POLL_65:
    global_load_dwordx4 v[136:139], v12, s[28:29] sc1
PWAIT_67:
    s_waitcnt vmcnt(0)
    v_xor_b32 v136, s31, v136
    v_xor_b32 v137, s32, v137
    v_xor_b32 v138, s33, v138
    v_xor_b32 v139, s34, v139
    v_or3_b32 v14, v136, v137, v138
    v_or_b32 v14, v139, v14
    v_cmp_ne_u32_sdwa vcc, v14, 0 src0_sel:BYTE_0 src1_sel:DWORD
    s_cbranch_vccz PDONE_66
    s_add_u32 s58, s58, 1
    s_cmp_lt_u32 s58, 60000
    s_cbranch_scc1 POLL_65
PDONE_66:
    s_barrier
    v_max_f32_dpp v14, v136, v136 quad_perm:[1,0,3,2] row_mask:0xf bank_mask:0xf
    v_max_f32_dpp v15, v138, v138 quad_perm:[1,0,3,2] row_mask:0xf bank_mask:0xf
    s_nop 0
    v_max_f32_dpp v14, v14, v14 quad_perm:[2,3,0,1] row_mask:0xf bank_mask:0xf
    v_max_f32_dpp v15, v15, v15 quad_perm:[2,3,0,1] row_mask:0xf bank_mask:0xf
    s_nop 0
    v_max_f32_dpp v14, v14, v14 row_half_mirror row_mask:0xf bank_mask:0xf
    v_max_f32_dpp v15, v15, v15 row_half_mirror row_mask:0xf bank_mask:0xf
    s_nop 0
    v_max_f32_dpp v14, v14, v14 row_mirror row_mask:0xf bank_mask:0xf
    v_max_f32_dpp v15, v15, v15 row_mirror row_mask:0xf bank_mask:0xf
    v_sub_f32 v14, v136, v14
    v_sub_f32 v15, v138, v15
    v_exp_f32 v14, v14
    v_exp_f32 v15, v15
    v_mul_f32 v16, v14, v137
    v_mul_f32 v17, v15, v139
    s_nop 0
    v_add_f32_dpp v16, v16, v16 quad_perm:[1,0,3,2] row_mask:0xf bank_mask:0xf
    v_add_f32_dpp v17, v17, v17 quad_perm:[1,0,3,2] row_mask:0xf bank_mask:0xf
    s_nop 0
    v_add_f32_dpp v16, v16, v16 quad_perm:[2,3,0,1] row_mask:0xf bank_mask:0xf
    v_add_f32_dpp v17, v17, v17 quad_perm:[2,3,0,1] row_mask:0xf bank_mask:0xf
    s_nop 0
    v_add_f32_dpp v16, v16, v16 row_half_mirror row_mask:0xf bank_mask:0xf
    v_add_f32_dpp v17, v17, v17 row_half_mirror row_mask:0xf bank_mask:0xf
    s_nop 0
    v_add_f32_dpp v16, v16, v16 row_mirror row_mask:0xf bank_mask:0xf
    v_add_f32_dpp v17, v17, v17 row_mirror row_mask:0xf bank_mask:0xf
    v_rcp_f32 v16, v16
    v_rcp_f32 v17, v17
    v_mul_f32 v14, v14, v16
    v_mul_f32 v15, v15, v17
    ds_write_b64 v13, v[14:15] offset:16688
    s_waitcnt lgkmcnt(0)
    s_barrier
    s_barrier
    ds_read_b128 v[40:43], v104 offset:0
    ds_read_b128 v[44:47], v104 offset:1280
    ds_read_b128 v[48:51], v104 offset:2560
    ds_read_b128 v[52:55], v104 offset:3840
    s_waitcnt lgkmcnt(2)
    v_pk_add_f32 v[40:41], v[40:41], v[44:45]
    v_pk_add_f32 v[42:43], v[42:43], v[46:47]
    s_waitcnt lgkmcnt(1)
    v_pk_add_f32 v[40:41], v[40:41], v[48:49]
    v_pk_add_f32 v[42:43], v[42:43], v[50:51]
    s_waitcnt lgkmcnt(0)
    v_pk_add_f32 v[40:41], v[40:41], v[52:53]
    v_pk_add_f32 v[42:43], v[42:43], v[54:55]
    s_nop 0
    v_add_f32_dpp v40, v40, v40 row_ror:4 row_mask:0xf bank_mask:0xf
    v_add_f32_dpp v41, v41, v41 row_ror:4 row_mask:0xf bank_mask:0xf
    v_add_f32_dpp v42, v42, v42 row_ror:4 row_mask:0xf bank_mask:0xf
    v_add_f32_dpp v43, v43, v43 row_ror:4 row_mask:0xf bank_mask:0xf
    v_add_f32_dpp v40, v40, v40 row_ror:8 row_mask:0xf bank_mask:0xf
    v_add_f32_dpp v41, v41, v41 row_ror:8 row_mask:0xf bank_mask:0xf
    v_add_f32_dpp v42, v42, v42 row_ror:8 row_mask:0xf bank_mask:0xf
    v_add_f32_dpp v43, v43, v43 row_ror:8 row_mask:0xf bank_mask:0xf
    v_bfi_b32 v40, v9, s31, v40
    v_bfi_b32 v41, v9, s32, v41
    v_bfi_b32 v42, v9, s33, v42
    v_bfi_b32 v43, v9, s34, v43
    global_store_dwordx4 v105, v[40:43], s[28:29] sc1
    global_store_dwordx4 v105, v[40:43], s[44:45] sc1
    s_endpgm
L_FIN:
L_END:
    s_endpgm
.p2align 10
L_CODE_END:
.section .rodata,"a"
.p2align 6
.amdhsa_kernel sequential_preLN__sliding_block_cached__mixer_channel_mlp__decode_kernel
  .amdhsa_next_free_vgpr 168
  .amdhsa_next_free_sgpr 102
  .amdhsa_accum_offset 168
  .amdhsa_group_segment_fixed_size 0
  .amdhsa_kernarg_size 104
  .amdhsa_user_sgpr_count 2
  .amdhsa_user_sgpr_kernarg_segment_ptr 1
  .amdhsa_system_sgpr_workgroup_id_x 1
.end_amdhsa_kernel
```
